```python
import torch

def _softmax(x, axis=-1):
    return torch.softmax(x, dim=axis)
def _gelu(x):
    return torch.nn.functional.gelu(x, approximate="tanh")
def _silu(x):
    return torch.nn.functional.silu(x)
def _sigmoid(x):
    return torch.sigmoid(x)
def _layernorm(x, axis=-1, eps=1e-5):
    m = x.mean(dim=axis, keepdim=True)
    v = x.var(dim=axis, keepdim=True, unbiased=False)
    return (x - m) / torch.sqrt(v + eps)
def _scatter_add(tgt, idx, src, axis=0):
    return tgt.clone().index_add_(axis, idx, src)
def _segment_sum(src, seg, n):
    out = torch.zeros((n,) + src.shape[1:], dtype=src.dtype)
    return out.index_add_(0, seg, src)
def _pad(x, pw):
    flat = tuple(v for pair in reversed(pw) for v in pair)
    return torch.nn.functional.pad(x, flat)

kernel_name = 'standalone__mixer_s_mlp__prompt'

def setup_inputs():

    _w = (lambda a: (lambda t: t.to(torch.bfloat16) if t.is_floating_point() else t)(torch.as_tensor(a)))
    B, S, D, F = 1, 2048, 448, 1792
    return {
        "x":  _w((lambda *s: torch.randn(*s, dtype=torch.bfloat16) * 0.4)(B, S, D)),
        "w1": _w((lambda *s: torch.randn(*s, dtype=torch.bfloat16) * 3.2)(D, D) * (D ** -0.5)),
        "w2": _w((lambda *s: torch.randn(*s, dtype=torch.bfloat16) * 3.2)(D, D) * (D ** -0.5)),
        "w3": _w((lambda *s: torch.randn(*s, dtype=torch.bfloat16) * 3.2)(D, F) * (D ** -0.5)),
        "w4": _w((lambda *s: torch.randn(*s, dtype=torch.bfloat16) * 0.8)(F, D) * (F ** -0.5)),
    }

def reference(x, w1, w2, w3, w4):
    B, S, D = x.shape
    h = _gelu(_layernorm(x, axis=-1) @ w1)
    c = D // 4
    g0 = _pad(h[:, :, 0*c:1*c], ((0, 0), (1, 0), (0, 0)))[:, :S, :]
    g1 = _pad(h[:, :, 1*c:2*c], ((0, 0), (0, 1), (0, 0)))[:, 1:, :]
    g2 = _pad(h[:, :, 2*c:3*c], ((0, 0), (2, 0), (0, 0)))[:, :S, :]
    g3 = _pad(h[:, :, 3*c:   ], ((0, 0), (0, 2), (0, 0)))[:, 2:, :]
    hs = torch.concatenate([g0, g1, g2, g3], axis=-1) @ w2
    x1 = x + hs
    h2 = _gelu(_layernorm(x1, axis=-1) @ w3) @ w4
    return x1 + h2
```

```asm
; @launch grid=(256,1,1) block=(256,1,1) lds=163840
.amdgcn_target "amdgcn-amd-amdhsa--gfx950"
.text
.p2align 12
.globl standalone__mixer_s_mlp__prompt_kernel
.p2align 8
.type standalone__mixer_s_mlp__prompt_kernel,@function
standalone__mixer_s_mlp__prompt_kernel:
s_cmp_ge_u32 s2, 256
s_cbranch_scc1 L_end
s_load_dwordx16 s[4:19], s[0:1], 0
s_getpc_b64 s[66:67]
L_pc0:
s_lshr_b32 s58, s2, 3
s_mul_i32 s58, s58, 32
v_and_b32 v1, 31, v0
v_add_lshl_u32 v1, v1, s58, 7
v_min_u32 v1, L_end-L_pc0, v1
global_load_dword v255, v1, s[66:67]
s_bfe_u32 s56, s2, 0x40003
s_lshr_b32 s58, s2, 7
s_and_b32 s53, s2, 7
s_lshl1_add_u32 s53, s53, s58
s_cmp_lt_u32 s56, 2
s_cbranch_scc1 L_helper
v_lshrrev_b32 v2, 6, v0
v_and_b32 v1, 63, v0
v_readfirstlane_b32 s52, v2
s_sub_u32 s56, s56, 2
s_and_b32 s54, s56, 1
s_lshr_b32 s55, s56, 1
s_lshl1_add_u32 s57, s53, s54
s_and_b32 s58, s57, 3
s_lshl1_add_u32 s58, s58, s55
s_lshl_b32 s68, s58, 7
s_sub_u32 s58, s68, 896
s_cselect_b32 s68, s68, s58
s_lshl_b32 s57, s57, 6
v_bfe_u32 v2, v1, 2, 3
v_lshrrev_b32 v6, 5, v1
v_and_b32 v7, 3, v1
v_mul_u32_u24 v2, 896, v2
v_lshl_add_u32 v2, v6, 6, v2
v_lshl_add_u32 v8, v7, 4, v2
v_lshlrev_b32 v3, 1, v1
v_and_b32 v3, 32, v3
v_xor_b32 v12, v3, v8
v_lshlrev_b32 v5, 4, v1
s_lshl4_add_u32 s58, s52, s57
s_sub_u32 s58, s58, 2
s_mul_i32 s58, s58, 896
s_add_u32 s59, s57, s52
s_add_u32 s59, s59, 62
s_mul_i32 s59, s59, 896
v_add_u32 v224, s58, v12
v_add_u32 v226, s59, v5
v_add_u32 v225, 7168, v224
v_cmp_gt_u32 vcc, 56, v1
v_mov_b32 v4, 1073741824
s_mov_b32 s22, 1835008
s_mov_b32 s23, 0x20000
v_min_u32 v224, v4, v224
v_cndmask_b32 v226, v4, v226, vcc
s_mul_i32 s75, s52, 14336
s_mov_b32 s26, 401408
s_mov_b32 s27, 0x20000
s_and_b32 s65, s52, 1
s_lshl_b32 s64, s55, 7
s_lshl_b32 s60, s52, 11
s_lshr_b32 s59, s75, 1
s_add_u32 s59, s59, s64
s_lshl_b32 s58, s65, 5
v_xor_b32 v228, s58, v8
v_add_u32 v228, s59, v228
v_add_u32 v229, 27648, v228
v_add_u32 v12, s59, v12
v_add_u32 v13, 27648, v12
s_add_u32 s69, s68, 128
s_cmp_eq_u32 s69, 896
s_cselect_b32 s69, 0, s69
s_waitcnt lgkmcnt(0)
s_mov_b64 s[20:21], s[4:5]
s_add_u32 m0, s75, 0
buffer_load_dwordx4 v[244:247], v226, s[20:23], 0 offen
buffer_load_dwordx4 v224, s[20:23], s68 offen lds
s_add_u32 s70, s69, 128
s_cmp_eq_u32 s70, 896
s_cselect_b32 s70, 0, s70
s_add_u32 m0, s75, 7168
s_nop 0
buffer_load_dwordx4 v225, s[20:23], s68 offen lds
s_mov_b64 s[24:25], s[6:7]
s_add_u32 s71, s70, 128
s_cmp_eq_u32 s71, 896
s_cselect_b32 s71, 0, s71
s_add_u32 s72, s71, 128
s_cmp_eq_u32 s72, 896
s_cselect_b32 s72, 0, s72
s_add_u32 m0, s75, 1024
s_nop 0
buffer_load_dwordx4 v224, s[20:23], s69 offen lds
s_add_u32 s73, s72, 128
s_cmp_eq_u32 s73, 896
s_cselect_b32 s73, 0, s73
s_add_u32 m0, s75, 8192
s_nop 0
buffer_load_dwordx4 v225, s[20:23], s69 offen lds
s_add_u32 s74, s73, 128
s_cmp_eq_u32 s74, 896
s_cselect_b32 s74, 0, s74
v_and_b32 v16, 15, v1
v_lshrrev_b32 v17, 4, v1
v_and_b32 v18, 1, v17
v_mov_b32 v20, 0x3f803f80
v_mov_b32 v21, 0x3f803f80
v_mov_b32 v22, 0x3f803f80
v_mov_b32 v23, 0x3f803f80
v_mov_b32 v230, 0
v_mov_b32 v231, 0
v_lshrrev_b32 v2, 2, v1
s_lshr_b32 s58, s68, 6
v_subrev_u32 v2, s58, v2
v_add_u32 v3, 14, v2
s_add_u32 m0, s60, 65536
s_mul_i32 s61, s68, 448
buffer_load_dwordx4 v228, s[24:27], s61 offen lds
v_min_u32 v2, v2, v3
v_lshlrev_b32 v2, 9, v2
v_mov_b32 v3, 256
v_cndmask_b32 v2, v3, v2, vcc
v_lshl_add_u32 v2, v7, 4, v2
s_lshl_b32 s58, s52, 6
v_add_u32 v232, s58, v2
v_lshlrev_b32 v227, 4, v17
v_lshrrev_b32 v2, 3, v16
v_mul_u32_u24 v2, 6656, v2
v_lshl_add_u32 v2, v16, 6, v2
v_and_b32 v233, 4, v16
v_lshl_add_u32 v233, v233, 3, v2
buffer_load_dwordx4 v229, s[24:27], s61 offen offset:1024 lds
v_xor_b32 v233, v227, v233
v_add_u32 v233, s75, v233
v_lshrrev_b32 v2, 2, v16
v_cmp_eq_u32 s[76:77], v2, v17
v_lshlrev_b32 v2, 6, v2
v_lshl_add_u32 v2, v7, 3, v2
v_lshl_add_u32 v19, v18, 5, v2
v_lshl_add_u32 v2, v17, 11, v19
s_lshl_b32 s58, s65, 5
v_xor_b32 v2, s58, v2
s_lshr_b32 s58, s52, 1
s_lshl_b32 s58, s58, 9
s_add_u32 m0, s75, 2048
s_add_u32 s58, s58, 65536
buffer_load_dwordx4 v224, s[20:23], s70 offen lds
v_add_u32 v234, s58, v2
s_lshl2_add_u32 s58, s55, s52
s_mul_i32 s58, s58, 37
s_lshr_b32 s58, s58, 8
s_lshl_b32 s58, s58, 2
s_lshr_b32 s58, 0x4031, s58
s_and_b32 s58, s58, 15
v_add_u32 v3, s58, v16
v_lshrrev_b32 v2, 3, v3
v_mul_u32_u24 v2, 6656, v2
v_lshl_add_u32 v2, v3, 6, v2
v_and_b32 v235, 4, v3
s_add_u32 m0, s75, 9216
v_lshl_add_u32 v235, v235, 3, v2
buffer_load_dwordx4 v225, s[20:23], s70 offen lds
v_xor_b32 v235, v227, v235
v_lshlrev_b32 v236, 3, v3
s_mov_b64 s[28:29], s[8:9]
s_mov_b32 s30, 401408
s_mov_b32 s31, 0x20000
s_mov_b64 s[32:33], s[10:11]
s_mov_b32 s34, 1605632
s_mov_b32 s35, 0x20000
s_mov_b64 s[36:37], s[12:13]
s_mov_b32 s38, 1605632
s_mov_b32 s39, 0x20000
s_mov_b64 s[40:41], s[14:15]
s_mov_b32 s42, 1835008
s_add_u32 m0, s60, 73728
s_mul_i32 s61, s69, 448
buffer_load_dwordx4 v228, s[24:27], s61 offen lds
s_mov_b32 s43, 0x20000
s_mov_b64 s[44:45], s[16:17]
s_mov_b32 s46, 256
s_mov_b32 s47, 0x20000
s_mov_b64 s[48:49], s[18:19]
s_mov_b32 s50, 33554432
s_mov_b32 s51, 0x20000
v_add_u32 v3, 2, v16
v_lshrrev_b32 v2, 3, v3
v_mul_u32_u24 v2, 6656, v2
v_lshl_add_u32 v2, v3, 6, v2
v_and_b32 v238, 4, v3
v_lshl_add_u32 v238, v238, 3, v2
buffer_load_dwordx4 v229, s[24:27], s61 offen offset:1024 lds
v_lshl_add_u32 v238, v17, 3, v238
s_sub_u32 s58, s64, s68
s_cselect_b32 s59, 896, 0
s_add_u32 s58, s58, s59
s_lshl3_add_u32 s58, s58, s75
v_add_u32 v238, s58, v238
v_xor_b32 v239, 32, v238
s_lshl_b32 s58, s52, 4
v_add_u32 v2, s58, v16
s_add_u32 s58, s52, 64
v_mov_b32 v3, s58
v_cndmask_b32 v2, v3, v2, s[76:77]
v_lshlrev_b32 v237, 3, v2
s_mov_b32 s78, 0xaaaaaaaa
s_mov_b32 s80, 0xcccccccc
s_mov_b32 s79, 0xaaaaaaaa
s_mov_b32 s81, 0xcccccccc
s_mov_b32 s82, 0x3eeff558
s_mov_b32 s84, 0x409d30fc
s_mov_b32 s83, 0x3eeff558
s_mov_b32 s85, 0x409d30fc
s_mov_b32 s62, 400000
s_mov_b32 s63, 64
v_bfe_u32 v2, v1, 2, 2
v_mul_u32_u24 v2, 3584, v2
v_lshl_add_u32 v2, v17, 6, v2
v_lshl_add_u32 v2, v7, 4, v2
s_lshl_b32 s58, s56, 8
s_add_u32 s58, s58, s75
v_add_u32 v14, s58, v2
v_add_u32 v15, 56320, v14
s_lshl_b32 s86, s53, 4
v_lshlrev_b32 v2, 11, v6
v_lshl_add_u32 v2, v18, 8, v2
v_lshl_add_u32 v2, v16, 4, v2
s_lshl_b32 s58, s52, 9
v_add_u32 v242, s58, v2
s_lshl_b32 s90, s53, 21
s_and_b32 s58, s53, 1
s_lshl_b32 s58, s58, 14
s_add_u32 s91, s90, s58
s_mul_i32 s89, s54, 114688
s_add_u32 s89, s89, 16384
s_mul_i32 s58, s55, 16384
s_add_u32 s87, s89, s58
s_add_u32 s89, s89, s60
v_add_u32 v64, s89, v5
v_add_u32 v66, 40960, v242
s_add_u32 s58, s60, 40960
v_add_u32 v67, s58, v5
s_lshl_b32 s4, s55, 13
s_cmp_ge_u32 s55, 1
s_cselect_b32 s5, 0, 1
s_lshl_b32 s5, s5, 13
s_cmp_ge_u32 s55, 2
s_cselect_b32 s6, 1, 2
s_lshl_b32 s6, s6, 13
s_cmp_ge_u32 s55, 3
s_cselect_b32 s7, 2, 3
s_lshl_b32 s7, s7, 13
s_cmp_ge_u32 s55, 4
s_cselect_b32 s8, 3, 4
s_lshl_b32 s8, s8, 13
s_cmp_ge_u32 s55, 5
s_cselect_b32 s9, 4, 5
s_lshl_b32 s9, s9, 13
s_cmp_ge_u32 s55, 6
s_cselect_b32 s10, 5, 6
s_lshl_b32 s10, s10, 13
v_cmp_gt_u32 vcc, 8, v0
v_lshl_add_u32 v2, v0, 6, s55
s_lshl_b32 s58, s54, 10
v_cndmask_b32 v24, v4, v2, vcc
s_add_u32 s11, s90, s58
s_lshl3_add_u32 s12, s54, s90
s_lshl_b32 s58, s54, 12
s_add_u32 s59, s90, 3072
s_add_u32 s13, s59, s58
s_getreg_b32 s58, hwreg(HW_REG_XCC_ID, 0, 4)
s_or_b32 s58, s58, 0x80
v_mov_b32 v25, s58
s_mov_b32 s14, s58
s_mul_i32 s16, s58, 0x01010101
s_lshr_b32 s17, s16, 8
v_lshl_add_u32 v2, v6, 12, v19
v_lshl_add_u32 v2, v18, 8, v2
v_xor_b32 v3, 32, v2
v_add_u32 v29, 57344, v2
v_add_u32 v30, 114688, v2
v_add_u32 v31, 57344, v3
v_add_u32 v32, 114688, v3
v_lshl_add_u32 v2, v6, 11, v19
s_lshl_b32 s58, s52, 8
v_add_u32 v2, s58, v2
v_mov_b32 v33, v2
v_add_u32 v34, 57344, v2
s_add_u32 m0, s75, 3072
v_add_u32 v35, 114688, v2
buffer_load_dwordx4 v224, s[20:23], s71 offen lds
s_add_u32 m0, s75, 10240
s_nop 0
buffer_load_dwordx4 v225, s[20:23], s71 offen lds
s_add_u32 m0, s60, 81920
s_mul_i32 s61, s70, 448
buffer_load_dwordx4 v228, s[24:27], s61 offen lds
buffer_load_dwordx4 v229, s[24:27], s61 offen offset:1024 lds
s_waitcnt vmcnt(14)
ds_write_b128 v232, v[244:247] offset:57344
v_dot2c_f32_bf16 v230, v20, v244
v_dot2c_f32_bf16 v231, v244, v244
v_dot2c_f32_bf16 v230, v20, v245
v_dot2c_f32_bf16 v231, v245, v245
v_dot2c_f32_bf16 v230, v20, v246
v_dot2c_f32_bf16 v231, v246, v246
v_dot2c_f32_bf16 v230, v20, v247
v_dot2c_f32_bf16 v231, v247, v247
s_waitcnt vmcnt(12)
ds_read_b128 v[248:251], v233 offset:0
ds_read_b128 v[252:255], v233 offset:512
v_add_f32_dpp v230, v230, v230 quad_perm:[1,0,3,2] row_mask:0xf bank_mask:0xf
v_add_f32_dpp v231, v231, v231 quad_perm:[1,0,3,2] row_mask:0xf bank_mask:0xf
s_nop 0
v_add_f32_dpp v230, v230, v230 quad_perm:[2,3,0,1] row_mask:0xf bank_mask:0xf
v_add_f32_dpp v231, v231, v231 quad_perm:[2,3,0,1] row_mask:0xf bank_mask:0xf
s_nop 0
v_add_f32_dpp v230, v230, v230 row_half_mirror row_mask:0xf bank_mask:0xf
v_add_f32_dpp v231, v231, v231 row_half_mirror row_mask:0xf bank_mask:0xf
s_nop 0
v_add_f32_dpp v230, v230, v230 row_mirror row_mask:0xf bank_mask:0xf
v_add_f32_dpp v231, v231, v231 row_mirror row_mask:0xf bank_mask:0xf
s_waitcnt lgkmcnt(1)
v_mfma_f32_16x16x32_bf16 v[216:219], v[20:23], v[248:251], 0
v_mfma_f32_16x16x32_bf16 v[220:223], v[248:251], v[248:251], 0
s_waitcnt lgkmcnt(0)
v_mfma_f32_16x16x32_bf16 v[216:219], v[20:23], v[252:255], v[216:219]
v_mfma_f32_16x16x32_bf16 v[220:223], v[252:255], v[252:255], v[220:223]
s_waitcnt vmcnt(8)
s_barrier
ds_read_b128 v[248:251], v233 offset:1024
ds_read_b128 v[252:255], v233 offset:1536
ds_read_b64_tr_b16 v[112:113], v234 offset:0
ds_read_b64_tr_b16 v[114:115], v234 offset:256
ds_read_b128 v[128:131], v235 offset:0
ds_read_b128 v[132:135], v235 offset:14336
ds_read_b128 v[136:139], v235 offset:28672
ds_read_b128 v[140:143], v235 offset:43008
ds_read_b64_tr_b16 v[116:117], v234 offset:1024
ds_read_b64_tr_b16 v[118:119], v234 offset:1280
ds_read_b128 v[144:147], v235 offset:512
ds_read_b128 v[148:151], v235 offset:14848
ds_read_b128 v[152:155], v235 offset:29184
s_add_u32 m0, s75, 4096
ds_read_b128 v[156:159], v235 offset:43520
buffer_load_dwordx4 v224, s[20:23], s72 offen lds
s_add_u32 m0, s75, 11264
s_nop 0
buffer_load_dwordx4 v225, s[20:23], s72 offen lds
s_add_u32 m0, s60, 90112
s_mul_i32 s61, s71, 448
buffer_load_dwordx4 v228, s[24:27], s61 offen lds
buffer_load_dwordx4 v229, s[24:27], s61 offen offset:1024 lds
v_permlane32_swap_b32 v230, v231
v_add_f32 v230, v230, v231
v_mov_b32 v231, v230
s_nop 1
v_permlane16_swap_b32 v230, v231
v_add_f32 v230, v230, v231
v_mov_b32 v231, v230
s_nop 1
v_permlane32_swap_b32 v230, v231
s_waitcnt lgkmcnt(13)
v_mfma_f32_16x16x32_bf16 v[216:219], v[20:23], v[248:251], v[216:219]
v_mfma_f32_16x16x32_bf16 v[220:223], v[248:251], v[248:251], v[220:223]
s_waitcnt lgkmcnt(12)
v_mfma_f32_16x16x32_bf16 v[216:219], v[20:23], v[252:255], v[216:219]
v_mfma_f32_16x16x32_bf16 v[220:223], v[252:255], v[252:255], v[220:223]
s_waitcnt vmcnt(8) lgkmcnt(0)
s_barrier
v_mfma_f32_16x16x32_bf16 v[212:215], v[112:115], v[20:23], 0
ds_read_b128 v[248:251], v233 offset:2048
s_add_u32 m0, s75, 5120
ds_read_b128 v[252:255], v233 offset:2560
buffer_load_dwordx4 v224, s[20:23], s73 offen lds
v_mfma_f32_16x16x32_bf16 v[196:199], v[112:115], v[128:131], 0
ds_read_b64_tr_b16 v[120:121], v234 offset:8192
ds_read_b64_tr_b16 v[122:123], v234 offset:8448
v_mfma_f32_16x16x32_bf16 v[200:203], v[112:115], v[132:135], 0
ds_read_b128 v[160:163], v235 offset:1024
ds_read_b128 v[164:167], v235 offset:15360
v_mfma_f32_16x16x32_bf16 v[204:207], v[112:115], v[136:139], 0
s_add_u32 m0, s75, 12288
ds_read_b128 v[168:171], v235 offset:29696
buffer_load_dwordx4 v225, s[20:23], s73 offen lds
v_mfma_f32_16x16x32_bf16 v[208:211], v[112:115], v[140:143], 0
ds_read_b128 v[172:175], v235 offset:44032
ds_read_b64_tr_b16 v[124:125], v234 offset:9216
v_mfma_f32_16x16x32_bf16 v[212:215], v[116:119], v[20:23], v[212:215]
ds_read_b64_tr_b16 v[126:127], v234 offset:9472
ds_read_b128 v[176:179], v235 offset:1536
v_mfma_f32_16x16x32_bf16 v[196:199], v[116:119], v[144:147], v[196:199]
ds_read_b128 v[180:183], v235 offset:15872
ds_read_b128 v[184:187], v235 offset:30208
v_mfma_f32_16x16x32_bf16 v[200:203], v[116:119], v[148:151], v[200:203]
ds_read_b128 v[188:191], v235 offset:44544
s_add_u32 m0, s60, 98304
s_mul_i32 s61, s72, 448
buffer_load_dwordx4 v228, s[24:27], s61 offen lds
v_mfma_f32_16x16x32_bf16 v[204:207], v[116:119], v[152:155], v[204:207]
v_mfma_f32_16x16x32_bf16 v[208:211], v[116:119], v[156:159], v[208:211]
s_waitcnt lgkmcnt(13)
v_mfma_f32_16x16x32_bf16 v[216:219], v[20:23], v[248:251], v[216:219]
buffer_load_dwordx4 v229, s[24:27], s61 offen offset:1024 lds
v_mfma_f32_16x16x32_bf16 v[220:223], v[248:251], v[248:251], v[220:223]
s_waitcnt lgkmcnt(12)
v_mfma_f32_16x16x32_bf16 v[216:219], v[20:23], v[252:255], v[216:219]
v_mfma_f32_16x16x32_bf16 v[220:223], v[252:255], v[252:255], v[220:223]
s_waitcnt vmcnt(8) lgkmcnt(0)
s_barrier
v_mfma_f32_16x16x32_bf16 v[212:215], v[120:123], v[20:23], v[212:215]
ds_read_b128 v[248:251], v233 offset:3072
s_add_u32 m0, s75, 6144
ds_read_b128 v[252:255], v233 offset:3584
buffer_load_dwordx4 v224, s[20:23], s74 offen lds
v_mfma_f32_16x16x32_bf16 v[196:199], v[120:123], v[160:163], v[196:199]
ds_read_b64_tr_b16 v[112:113], v234 offset:16384
ds_read_b64_tr_b16 v[114:115], v234 offset:16640
v_mfma_f32_16x16x32_bf16 v[200:203], v[120:123], v[164:167], v[200:203]
ds_read_b128 v[128:131], v235 offset:2048
ds_read_b128 v[132:135], v235 offset:16384
v_mfma_f32_16x16x32_bf16 v[204:207], v[120:123], v[168:171], v[204:207]
s_add_u32 m0, s75, 13312
ds_read_b128 v[136:139], v235 offset:30720
buffer_load_dwordx4 v225, s[20:23], s74 offen lds
v_mfma_f32_16x16x32_bf16 v[208:211], v[120:123], v[172:175], v[208:211]
ds_read_b128 v[140:143], v235 offset:45056
ds_read_b64_tr_b16 v[116:117], v234 offset:17408
v_mfma_f32_16x16x32_bf16 v[212:215], v[124:127], v[20:23], v[212:215]
ds_read_b64_tr_b16 v[118:119], v234 offset:17664
ds_read_b128 v[144:147], v235 offset:2560
v_mfma_f32_16x16x32_bf16 v[196:199], v[124:127], v[176:179], v[196:199]
ds_read_b128 v[148:151], v235 offset:16896
ds_read_b128 v[152:155], v235 offset:31232
v_mfma_f32_16x16x32_bf16 v[200:203], v[124:127], v[180:183], v[200:203]
ds_read_b128 v[156:159], v235 offset:45568
s_add_u32 m0, s60, 106496
s_mul_i32 s61, s73, 448
buffer_load_dwordx4 v228, s[24:27], s61 offen lds
v_mfma_f32_16x16x32_bf16 v[204:207], v[124:127], v[184:187], v[204:207]
v_mfma_f32_16x16x32_bf16 v[208:211], v[124:127], v[188:191], v[208:211]
s_waitcnt lgkmcnt(13)
v_mfma_f32_16x16x32_bf16 v[216:219], v[20:23], v[248:251], v[216:219]
buffer_load_dwordx4 v229, s[24:27], s61 offen offset:1024 lds
v_mfma_f32_16x16x32_bf16 v[220:223], v[248:251], v[248:251], v[220:223]
s_waitcnt lgkmcnt(12)
v_mfma_f32_16x16x32_bf16 v[216:219], v[20:23], v[252:255], v[216:219]
v_mfma_f32_16x16x32_bf16 v[220:223], v[252:255], v[252:255], v[220:223]
s_waitcnt vmcnt(8) lgkmcnt(0)
s_barrier
v_mfma_f32_16x16x32_bf16 v[212:215], v[112:115], v[20:23], v[212:215]
ds_read_b128 v[248:251], v233 offset:4096
ds_read_b128 v[252:255], v233 offset:4608
s_add_u32 m0, s60, 114688
s_mul_i32 s61, s74, 448
buffer_load_dwordx4 v228, s[24:27], s61 offen lds
v_mfma_f32_16x16x32_bf16 v[196:199], v[112:115], v[128:131], v[196:199]
ds_read_b64_tr_b16 v[120:121], v234 offset:24576
ds_read_b64_tr_b16 v[122:123], v234 offset:24832
v_mfma_f32_16x16x32_bf16 v[200:203], v[112:115], v[132:135], v[200:203]
ds_read_b128 v[160:163], v235 offset:3072
ds_read_b128 v[164:167], v235 offset:17408
buffer_load_dwordx4 v229, s[24:27], s61 offen offset:1024 lds
v_mfma_f32_16x16x32_bf16 v[204:207], v[112:115], v[136:139], v[204:207]
ds_read_b128 v[168:171], v235 offset:31744
v_mfma_f32_16x16x32_bf16 v[208:211], v[112:115], v[140:143], v[208:211]
ds_read_b128 v[172:175], v235 offset:46080
ds_read_b64_tr_b16 v[124:125], v234 offset:25600
v_mfma_f32_16x16x32_bf16 v[212:215], v[116:119], v[20:23], v[212:215]
ds_read_b64_tr_b16 v[126:127], v234 offset:25856
ds_read_b128 v[176:179], v235 offset:3584
s_add_u32 m0, s60, 65536
s_mul_i32 s61, s4, 7
buffer_load_dwordx4 v12, s[28:31], s61 offen lds
v_mfma_f32_16x16x32_bf16 v[196:199], v[116:119], v[144:147], v[196:199]
ds_read_b128 v[180:183], v235 offset:17920
ds_read_b128 v[184:187], v235 offset:32256
v_mfma_f32_16x16x32_bf16 v[200:203], v[116:119], v[148:151], v[200:203]
ds_read_b128 v[188:191], v235 offset:46592
v_mfma_f32_16x16x32_bf16 v[204:207], v[116:119], v[152:155], v[204:207]
buffer_load_dwordx4 v13, s[28:31], s61 offen offset:1024 lds
v_mfma_f32_16x16x32_bf16 v[208:211], v[116:119], v[156:159], v[208:211]
s_waitcnt lgkmcnt(13)
v_mfma_f32_16x16x32_bf16 v[216:219], v[20:23], v[248:251], v[216:219]
v_mfma_f32_16x16x32_bf16 v[220:223], v[248:251], v[248:251], v[220:223]
s_add_u32 m0, s60, 73728
s_mul_i32 s61, s5, 7
buffer_load_dwordx4 v12, s[28:31], s61 offen lds
s_waitcnt lgkmcnt(12)
v_mfma_f32_16x16x32_bf16 v[216:219], v[20:23], v[252:255], v[216:219]
v_mfma_f32_16x16x32_bf16 v[220:223], v[252:255], v[252:255], v[220:223]
s_waitcnt vmcnt(9) lgkmcnt(0)
s_barrier
v_mfma_f32_16x16x32_bf16 v[212:215], v[120:123], v[20:23], v[212:215]
ds_read_b128 v[248:251], v233 offset:5120
ds_read_b128 v[252:255], v233 offset:5632
buffer_load_dwordx4 v13, s[28:31], s61 offen offset:1024 lds
v_mfma_f32_16x16x32_bf16 v[196:199], v[120:123], v[160:163], v[196:199]
ds_read_b64_tr_b16 v[112:113], v234 offset:32768
ds_read_b64_tr_b16 v[114:115], v234 offset:33024
v_mfma_f32_16x16x32_bf16 v[200:203], v[120:123], v[164:167], v[200:203]
ds_read_b128 v[128:131], v235 offset:4096
ds_read_b128 v[132:135], v235 offset:18432
v_mfma_f32_16x16x32_bf16 v[204:207], v[120:123], v[168:171], v[204:207]
ds_read_b128 v[136:139], v235 offset:32768
s_add_u32 m0, s60, 155648
s_mul_i32 s61, s6, 7
buffer_load_dwordx4 v12, s[28:31], s61 offen lds
v_mfma_f32_16x16x32_bf16 v[208:211], v[120:123], v[172:175], v[208:211]
ds_read_b128 v[140:143], v235 offset:47104
ds_read_b64_tr_b16 v[116:117], v234 offset:33792
v_mfma_f32_16x16x32_bf16 v[212:215], v[124:127], v[20:23], v[212:215]
ds_read_b64_tr_b16 v[118:119], v234 offset:34048
ds_read_b128 v[144:147], v235 offset:4608
v_mfma_f32_16x16x32_bf16 v[196:199], v[124:127], v[176:179], v[196:199]
ds_read_b128 v[148:151], v235 offset:18944
ds_read_b128 v[152:155], v235 offset:33280
v_mfma_f32_16x16x32_bf16 v[200:203], v[124:127], v[180:183], v[200:203]
ds_read_b128 v[156:159], v235 offset:47616
buffer_load_dwordx4 v13, s[28:31], s61 offen offset:1024 lds
v_mfma_f32_16x16x32_bf16 v[204:207], v[124:127], v[184:187], v[204:207]
v_mfma_f32_16x16x32_bf16 v[208:211], v[124:127], v[188:191], v[208:211]
s_waitcnt lgkmcnt(13)
v_mfma_f32_16x16x32_bf16 v[216:219], v[20:23], v[248:251], v[216:219]
s_add_u32 m0, s60, 81920
s_mul_i32 s61, s7, 7
buffer_load_dwordx4 v12, s[28:31], s61 offen lds
v_mfma_f32_16x16x32_bf16 v[220:223], v[248:251], v[248:251], v[220:223]
s_waitcnt lgkmcnt(12)
v_mfma_f32_16x16x32_bf16 v[216:219], v[20:23], v[252:255], v[216:219]
v_mfma_f32_16x16x32_bf16 v[220:223], v[252:255], v[252:255], v[220:223]
s_waitcnt vmcnt(9) lgkmcnt(0)
s_barrier
v_mfma_f32_16x16x32_bf16 v[212:215], v[112:115], v[20:23], v[212:215]
ds_read_b128 v[248:251], v233 offset:6144
ds_read_b128 v[252:255], v233 offset:6656
buffer_load_dwordx4 v13, s[28:31], s61 offen offset:1024 lds
v_mfma_f32_16x16x32_bf16 v[196:199], v[112:115], v[128:131], v[196:199]
ds_read_b64_tr_b16 v[120:121], v234 offset:40960
ds_read_b64_tr_b16 v[122:123], v234 offset:41216
v_mfma_f32_16x16x32_bf16 v[200:203], v[112:115], v[132:135], v[200:203]
ds_read_b128 v[160:163], v235 offset:5120
ds_read_b128 v[164:167], v235 offset:19456
v_mfma_f32_16x16x32_bf16 v[204:207], v[112:115], v[136:139], v[204:207]
ds_read_b128 v[168:171], v235 offset:33792
s_add_u32 m0, s60, 90112
s_mul_i32 s61, s8, 7
buffer_load_dwordx4 v12, s[28:31], s61 offen lds
v_mfma_f32_16x16x32_bf16 v[208:211], v[112:115], v[140:143], v[208:211]
ds_read_b128 v[172:175], v235 offset:48128
ds_read_b64_tr_b16 v[124:125], v234 offset:41984
v_mfma_f32_16x16x32_bf16 v[212:215], v[116:119], v[20:23], v[212:215]
ds_read_b64_tr_b16 v[126:127], v234 offset:42240
ds_read_b128 v[176:179], v235 offset:5632
v_mfma_f32_16x16x32_bf16 v[196:199], v[116:119], v[144:147], v[196:199]
ds_read_b128 v[180:183], v235 offset:19968
ds_read_b128 v[184:187], v235 offset:34304
v_mfma_f32_16x16x32_bf16 v[200:203], v[116:119], v[148:151], v[200:203]
ds_read_b128 v[188:191], v235 offset:48640
buffer_load_dwordx4 v13, s[28:31], s61 offen offset:1024 lds
v_mfma_f32_16x16x32_bf16 v[204:207], v[116:119], v[152:155], v[204:207]
v_mfma_f32_16x16x32_bf16 v[208:211], v[116:119], v[156:159], v[208:211]
s_waitcnt lgkmcnt(13)
v_mfma_f32_16x16x32_bf16 v[216:219], v[20:23], v[248:251], v[216:219]
s_add_u32 m0, s60, 98304
s_mul_i32 s61, s9, 7
buffer_load_dwordx4 v12, s[28:31], s61 offen lds
v_mfma_f32_16x16x32_bf16 v[220:223], v[248:251], v[248:251], v[220:223]
s_waitcnt lgkmcnt(12)
v_mfma_f32_16x16x32_bf16 v[216:219], v[20:23], v[252:255], v[216:219]
v_mfma_f32_16x16x32_bf16 v[220:223], v[252:255], v[252:255], v[220:223]
s_waitcnt vmcnt(11) lgkmcnt(0)
s_barrier
v_mfma_f32_16x16x32_bf16 v[212:215], v[120:123], v[20:23], v[212:215]
ds_read_b64_tr_b16 v[112:113], v234 offset:49152
ds_read_b64_tr_b16 v[114:115], v234 offset:49408
buffer_load_dwordx4 v13, s[28:31], s61 offen offset:1024 lds
v_mfma_f32_16x16x32_bf16 v[196:199], v[120:123], v[160:163], v[196:199]
ds_read_b128 v[128:131], v235 offset:6144
ds_read_b128 v[132:135], v235 offset:20480
v_mfma_f32_16x16x32_bf16 v[200:203], v[120:123], v[164:167], v[200:203]
ds_read_b128 v[136:139], v235 offset:34816
ds_read_b128 v[140:143], v235 offset:49152
v_cndmask_b32 v230, v230, v216, s[76:77]
v_cndmask_b32 v220, v220, v221, s[78:79]
s_add_u32 m0, s60, 106496
s_mul_i32 s61, s10, 7
buffer_load_dwordx4 v12, s[28:31], s61 offen lds
v_mfma_f32_16x16x32_bf16 v[204:207], v[120:123], v[168:171], v[204:207]
ds_read_b64_tr_b16 v[116:117], v234 offset:50176
ds_read_b64_tr_b16 v[118:119], v234 offset:50432
v_cndmask_b32 v222, v222, v223, s[78:79]
v_cndmask_b32 v220, v220, v222, s[80:81]
v_mfma_f32_16x16x32_bf16 v[208:211], v[120:123], v[172:175], v[208:211]
ds_read_b128 v[144:147], v235 offset:6656
ds_read_b128 v[148:151], v235 offset:20992
v_cndmask_b32 v231, v231, v220, s[76:77]
v_mul_f32 v218, -v230, v230
v_mfma_f32_16x16x32_bf16 v[212:215], v[124:127], v[20:23], v[212:215]
ds_read_b128 v[152:155], v235 offset:35328
ds_read_b128 v[156:159], v235 offset:49664
v_mul_f32 v217, 0xbb124925, v230
v_fmamk_f32 v218, v231, 0x43e00000, v218
buffer_load_dwordx4 v13, s[28:31], s61 offen offset:1024 lds
v_mfma_f32_16x16x32_bf16 v[196:199], v[124:127], v[176:179], v[196:199]
ds_read_b64 v[56:57], v238 offset:0
ds_read_b64 v[58:59], v239 offset:0
v_cmp_lt_f32 s[66:67], 0, v218
v_add_f32 v218, 0x40007358, v218
v_mfma_f32_16x16x32_bf16 v[200:203], v[124:127], v[180:183], v[200:203]
ds_read_b64 v[60:61], v238 offset:512
ds_read_b64 v[62:63], v239 offset:512
v_rsq_f32 v218, v218
s_add_u32 m0, s60, 122880
s_mov_b32 s61, 0
buffer_load_dwordx4 v14, s[32:35], s61 offen lds
v_mfma_f32_16x16x32_bf16 v[204:207], v[124:127], v[184:187], v[204:207]
v_mul_f32 v216, 0x4351f6ad, v218
v_cndmask_b32 v216, 0, v216, s[66:67]
v_mfma_f32_16x16x32_bf16 v[208:211], v[124:127], v[188:191], v[208:211]
ds_write_b64 v237, v[216:217] offset:64512
s_waitcnt lgkmcnt(0)
s_barrier
v_mfma_f32_16x16x32_bf16 v[212:215], v[112:115], v[20:23], v[212:215]
ds_read_b64 v[104:105], v236 offset:64512
buffer_load_dwordx4 v15, s[32:35], s61 offen offset:1024 lds
v_mfma_f32_16x16x32_bf16 v[196:199], v[112:115], v[128:131], v[196:199]
v_mfma_f32_16x16x32_bf16 v[200:203], v[112:115], v[132:135], v[200:203]
ds_read_b64 v[106:107], v236 offset:64640
s_add_u32 m0, s60, 0
s_mov_b32 s61, 114688
buffer_load_dwordx4 v14, s[32:35], s61 offen lds
v_mfma_f32_16x16x32_bf16 v[204:207], v[112:115], v[136:139], v[204:207]
v_mfma_f32_16x16x32_bf16 v[208:211], v[112:115], v[140:143], v[208:211]
ds_read_b64 v[108:109], v236 offset:64768
buffer_load_dwordx4 v15, s[32:35], s61 offen offset:1024 lds
v_mfma_f32_16x16x32_bf16 v[212:215], v[116:119], v[20:23], v[212:215]
v_mfma_f32_16x16x32_bf16 v[196:199], v[116:119], v[144:147], v[196:199]
ds_read_b64 v[110:111], v236 offset:64896
s_add_u32 m0, s60, 8192
s_mov_b32 s61, 229376
buffer_load_dwordx4 v14, s[32:35], s61 offen lds
v_mfma_f32_16x16x32_bf16 v[200:203], v[116:119], v[148:151], v[200:203]
v_mfma_f32_16x16x32_bf16 v[204:207], v[116:119], v[152:155], v[204:207]
buffer_load_dwordx4 v15, s[32:35], s61 offen offset:1024 lds
v_mfma_f32_16x16x32_bf16 v[208:211], v[116:119], v[156:159], v[208:211]
s_waitcnt lgkmcnt(3)
v_pk_fma_f32 v[196:197], v[212:213], v[104:105], v[196:197] op_sel:[0,1,0]
v_pk_fma_f32 v[198:199], v[214:215], v[104:105], v[198:199] op_sel:[0,1,0]
s_waitcnt lgkmcnt(2)
s_nop 0
v_pk_fma_f32 v[200:201], v[212:213], v[106:107], v[200:201] op_sel:[0,1,0]
v_pk_fma_f32 v[202:203], v[214:215], v[106:107], v[202:203] op_sel:[0,1,0]
v_pk_mul_f32 v[196:197], v[196:197], v[104:105] op_sel_hi:[1,0]
v_pk_mul_f32 v[198:199], v[198:199], v[104:105] op_sel_hi:[1,0]
v_pk_mul_f32 v[200:201], v[200:201], v[106:107] op_sel_hi:[1,0]
v_pk_mul_f32 v[202:203], v[202:203], v[106:107] op_sel_hi:[1,0]
v_pk_fma_f32 v[112:113], v[196:197], v[196:197], s[84:85] neg_lo:[1,0,1] neg_hi:[1,0,1]
v_pk_fma_f32 v[114:115], v[198:199], v[198:199], s[84:85] neg_lo:[1,0,1] neg_hi:[1,0,1]
v_pk_fma_f32 v[116:117], v[200:201], v[200:201], s[84:85] neg_lo:[1,0,1] neg_hi:[1,0,1]
s_add_u32 m0, s60, 16384
s_mov_b32 s61, 344064
buffer_load_dwordx4 v14, s[32:35], s61 offen lds
v_pk_fma_f32 v[118:119], v[202:203], v[202:203], s[84:85] neg_lo:[1,0,1] neg_hi:[1,0,1]
v_pk_mul_f32 v[112:113], v[196:197], v[112:113]
v_pk_mul_f32 v[114:115], v[198:199], v[114:115]
v_pk_mul_f32 v[116:117], v[200:201], v[116:117]
v_pk_mul_f32 v[118:119], v[202:203], v[118:119]
v_exp_f32 v112, v112
v_exp_f32 v113, v113
v_exp_f32 v114, v114
v_exp_f32 v115, v115
v_exp_f32 v116, v116
s_waitcnt lgkmcnt(0)
s_buffer_load_dword s0, s[44:47], s86 offset:0
v_exp_f32 v117, v117
v_exp_f32 v118, v118
v_exp_f32 v119, v119
v_pk_fma_f32 v[112:113], v[112:113], s[82:83], s[82:83]
v_pk_fma_f32 v[114:115], v[114:115], s[82:83], s[82:83]
buffer_load_dwordx4 v15, s[32:35], s61 offen offset:1024 lds
v_pk_fma_f32 v[116:117], v[116:117], s[82:83], s[82:83]
v_pk_fma_f32 v[118:119], v[118:119], s[82:83], s[82:83]
v_rcp_f32 v112, v112
v_rcp_f32 v113, v113
v_rcp_f32 v114, v114
v_rcp_f32 v115, v115
v_rcp_f32 v116, v116
v_rcp_f32 v117, v117
v_rcp_f32 v118, v118
v_rcp_f32 v119, v119
v_pk_mul_f32 v[196:197], v[196:197], v[112:113]
v_pk_mul_f32 v[198:199], v[198:199], v[114:115]
v_pk_mul_f32 v[200:201], v[200:201], v[116:117]
v_pk_mul_f32 v[202:203], v[202:203], v[118:119]
s_add_u32 m0, s60, 24576
s_mov_b32 s61, 458752
buffer_load_dwordx4 v14, s[32:35], s61 offen lds
v_cvt_pk_bf16_f32 v120, v196, v197
v_cvt_pk_bf16_f32 v121, v198, v199
v_cvt_pk_bf16_f32 v122, v200, v201
v_cvt_pk_bf16_f32 v123, v202, v203
s_nop 0
v_permlane32_swap_b32 v120, v122
v_permlane32_swap_b32 v121, v123
v_pk_fma_f32 v[204:205], v[212:213], v[108:109], v[204:205] op_sel:[0,1,0]
v_pk_fma_f32 v[206:207], v[214:215], v[108:109], v[206:207] op_sel:[0,1,0]
v_pk_fma_f32 v[208:209], v[212:213], v[110:111], v[208:209] op_sel:[0,1,0]
v_pk_fma_f32 v[210:211], v[214:215], v[110:111], v[210:211] op_sel:[0,1,0]
v_pk_mul_f32 v[204:205], v[204:205], v[108:109] op_sel_hi:[1,0]
v_pk_mul_f32 v[206:207], v[206:207], v[108:109] op_sel_hi:[1,0]
v_pk_mul_f32 v[208:209], v[208:209], v[110:111] op_sel_hi:[1,0]
v_pk_mul_f32 v[210:211], v[210:211], v[110:111] op_sel_hi:[1,0]
v_pk_fma_f32 v[112:113], v[204:205], v[204:205], s[84:85] neg_lo:[1,0,1] neg_hi:[1,0,1]
buffer_load_dwordx4 v15, s[32:35], s61 offen offset:1024 lds
v_pk_fma_f32 v[114:115], v[206:207], v[206:207], s[84:85] neg_lo:[1,0,1] neg_hi:[1,0,1]
v_pk_fma_f32 v[116:117], v[208:209], v[208:209], s[84:85] neg_lo:[1,0,1] neg_hi:[1,0,1]
v_pk_fma_f32 v[118:119], v[210:211], v[210:211], s[84:85] neg_lo:[1,0,1] neg_hi:[1,0,1]
v_pk_mul_f32 v[112:113], v[204:205], v[112:113]
v_pk_mul_f32 v[114:115], v[206:207], v[114:115]
v_pk_mul_f32 v[116:117], v[208:209], v[116:117]
v_pk_mul_f32 v[118:119], v[210:211], v[118:119]
v_exp_f32 v112, v112
v_exp_f32 v113, v113
v_exp_f32 v114, v114
v_exp_f32 v115, v115
v_exp_f32 v116, v116
v_exp_f32 v117, v117
v_exp_f32 v118, v118
v_exp_f32 v119, v119
s_add_u32 m0, s60, 32768
s_mov_b32 s61, 573440
buffer_load_dwordx4 v14, s[32:35], s61 offen lds
v_pk_fma_f32 v[112:113], v[112:113], s[82:83], s[82:83]
v_pk_fma_f32 v[114:115], v[114:115], s[82:83], s[82:83]
v_pk_fma_f32 v[116:117], v[116:117], s[82:83], s[82:83]
v_pk_fma_f32 v[118:119], v[118:119], s[82:83], s[82:83]
v_rcp_f32 v112, v112
v_rcp_f32 v113, v113
v_rcp_f32 v114, v114
v_rcp_f32 v115, v115
v_rcp_f32 v116, v116
v_rcp_f32 v117, v117
v_rcp_f32 v118, v118
v_rcp_f32 v119, v119
v_pk_mul_f32 v[204:205], v[204:205], v[112:113]
v_pk_mul_f32 v[206:207], v[206:207], v[114:115]
buffer_load_dwordx4 v15, s[32:35], s61 offen offset:1024 lds
v_pk_mul_f32 v[208:209], v[208:209], v[116:117]
v_pk_mul_f32 v[210:211], v[210:211], v[118:119]
v_cvt_pk_bf16_f32 v124, v204, v205
v_cvt_pk_bf16_f32 v125, v206, v207
v_cvt_pk_bf16_f32 v126, v208, v209
v_cvt_pk_bf16_f32 v127, v210, v211
s_waitcnt lgkmcnt(0)
s_cmp_eq_u32 s0, 0
s_cbranch_scc1 L_spinr
L_backr:
s_and_b32 s58, s0, 0x2000
s_add_u32 s91, s91, s58
s_add_u32 s87, s87, s91
s_add_u32 s88, s87, 4096
v_permlane32_swap_b32 v124, v126
v_permlane32_swap_b32 v125, v127
buffer_store_dwordx4 v[120:123], v242, s[48:51], s87 offen sc1
buffer_store_dwordx4 v[124:127], v242, s[48:51], s88 offen sc1
ds_write_b128 v66, v[120:123] offset:0
ds_write_b128 v66, v[124:127] offset:4096
s_waitcnt vmcnt(14) lgkmcnt(0)
s_barrier
ds_read_b128 v[72:75], v67 offset:0
ds_read_b128 v[76:79], v67 offset:1024
ds_read_b64_tr_b16 a[0:1], v29 offset:8192
s_mul_i32 s58, s54, 114688
s_mul_i32 s68, s4, 28
ds_read_b64_tr_b16 a[2:3], v29 offset:10240
s_add_u32 s68, s68, s58
s_lshl_b32 s4, s4, 1
s_mul_i32 s69, s5, 28
ds_read_b64_tr_b16 a[4:5], v31 offset:8192
s_add_u32 s69, s69, s58
s_lshl_b32 s5, s5, 1
s_add_u32 m0, s60, 49152
s_mov_b32 s61, 688128
buffer_load_dwordx4 v14, s[32:35], s61 offen lds
ds_read_b64_tr_b16 a[6:7], v31 offset:10240
s_mul_i32 s70, s6, 28
s_add_u32 s70, s70, s58
s_lshl_b32 s6, s6, 1
ds_read_b64_tr_b16 a[8:9], v29 offset:8704
s_mul_i32 s71, s7, 28
s_add_u32 s71, s71, s58
ds_read_b64_tr_b16 a[10:11], v29 offset:10752
s_lshl_b32 s7, s7, 1
s_mul_i32 s72, s8, 28
s_add_u32 s72, s72, s58
ds_read_b64_tr_b16 a[12:13], v31 offset:8704
s_lshl_b32 s8, s8, 1
s_mul_i32 s73, s9, 28
buffer_load_dwordx4 v15, s[32:35], s61 offen offset:1024 lds
ds_read_b64_tr_b16 a[14:15], v31 offset:10752
s_add_u32 s73, s73, s58
s_lshl_b32 s9, s9, 1
s_mul_i32 s74, s10, 28
ds_read_b64_tr_b16 a[16:17], v29 offset:9216
s_add_u32 s74, s74, s58
s_lshl_b32 s10, s10, 1
ds_read_b64_tr_b16 a[18:19], v29 offset:11264
s_mul_i32 s58, s54, 458752
s_add_u32 s20, s91, s58
s_add_u32 s20, s20, s60
ds_read_b64_tr_b16 a[20:21], v31 offset:9216
s_add_u32 s20, s20, 573440
s_add_u32 s18, s20, s4
s_add_u32 m0, s60, 57344
s_mov_b32 s61, 802816
buffer_load_dwordx4 v14, s[32:35], s61 offen lds
ds_read_b64_tr_b16 a[22:23], v31 offset:11264
s_add_u32 s19, s18, 114688
s_lshr_b32 s59, s60, 1
s_add_u32 s59, s59, s91
ds_read_b64_tr_b16 a[24:25], v29 offset:9728
s_add_u32 s59, s59, s4
s_add_u32 s59, s59, 1490944
ds_read_b64_tr_b16 a[26:27], v29 offset:11776
s_lshr_b32 s58, s58, 2
s_add_u32 s24, s59, s58
ds_read_b64_tr_b16 a[28:29], v31 offset:9728
s_sub_u32 s58, 114688, s58
s_add_u32 s23, s59, s58
s_lshl4_add_u32 s58, s52, s55
buffer_load_dwordx4 v15, s[32:35], s61 offen offset:1024 lds
ds_read_b64_tr_b16 a[30:31], v31 offset:11776
s_lshl3_add_u32 s58, s54, s58
s_lshl2_add_u32 s21, s58, s90
ds_read_b64_tr_b16 a[32:33], v29 offset:16384
s_add_u32 s21, s21, 11264
s_xor_b32 s22, s21, 32
s_add_u32 s25, s91, 245760
ds_read_b64_tr_b16 a[34:35], v29 offset:18432
s_add_u32 s27, s91, 299008
s_lshr_b32 s58, s52, 1
ds_read_b64_tr_b16 a[36:37], v31 offset:16384
s_lshl1_add_u32 s58, s54, s58
s_mul_i32 s58, s58, 81920
s_add_u32 s26, s25, s58
ds_read_b64_tr_b16 a[38:39], v31 offset:18432
s_add_u32 s28, s27, s58
s_lshr_b32 s58, s55, 1
ds_read_b64_tr_b16 a[40:41], v29 offset:16896
s_mul_i32 s58, s58, 8192
s_add_u32 s26, s26, s58
s_lshl4_add_u32 s59, s55, s65
ds_read_b64_tr_b16 a[42:43], v29 offset:18944
s_lshl_b32 s59, s59, 8
s_add_u32 s26, s26, s59
ds_read_b64_tr_b16 a[44:45], v31 offset:16896
s_lshl1_add_u32 s59, s55, s65
s_lshl_b32 s59, s59, 7
s_add_u32 s28, s28, s59
ds_read_b64_tr_b16 a[46:47], v31 offset:18944
s_mul_i32 s58, s52, 28672
s_add_u32 s58, s58, s64
v_add_u32 v64, s91, v64
s_lshl_b32 s59, s52, 5
v_xor_b32 v8, s59, v8
v_add_u32 v8, s58, v8
v_add_u32 v9, 6144, v8
v_add_u32 v10, 12288, v8
v_add_u32 v11, 18432, v8
v_lshlrev_b32 v128, 16, v56
v_and_b32 v129, 0xffff0000, v56
v_lshlrev_b32 v130, 16, v57
v_and_b32 v131, 0xffff0000, v57
v_lshlrev_b32 v132, 16, v58
v_and_b32 v133, 0xffff0000, v58
v_lshlrev_b32 v134, 16, v59
v_and_b32 v135, 0xffff0000, v59
v_lshlrev_b32 v136, 16, v60
v_and_b32 v137, 0xffff0000, v60
v_lshlrev_b32 v138, 16, v61
v_and_b32 v139, 0xffff0000, v61
v_lshlrev_b32 v140, 16, v62
v_and_b32 v141, 0xffff0000, v62
v_lshlrev_b32 v142, 16, v63
v_and_b32 v143, 0xffff0000, v63
v_lshlrev_b32 v2, 9, v17
v_lshl_add_u32 v36, v16, 4, v2
v_lshlrev_b32 v2, 6, v6
v_lshl_add_u32 v37, v16, 2, v2
v_mov_b32 v38, 0
v_mov_b32 v39, 0
s_waitcnt vmcnt(4)
s_barrier
buffer_store_byte v25, v24, s[48:51], s11 offen
ds_read_b64_tr_b16 a[48:49], v29 offset:17408
ds_read_b64_tr_b16 a[50:51], v29 offset:19456
ds_read_b64_tr_b16 a[52:53], v31 offset:17408
ds_read_b64_tr_b16 a[54:55], v31 offset:19456
ds_read_b64_tr_b16 a[56:57], v29 offset:17920
ds_read_b64_tr_b16 a[58:59], v29 offset:19968
s_add_u32 m0, s60, 114688
s_mov_b32 s61, 917504
buffer_load_dwordx4 v14, s[32:35], s61 offen lds
ds_read_b64_tr_b16 a[60:61], v31 offset:17920
ds_read_b64_tr_b16 a[62:63], v31 offset:19968
ds_read_b64_tr_b16 a[64:65], v30 offset:40960
ds_read_b64_tr_b16 a[66:67], v30 offset:43008
ds_read_b64_tr_b16 a[68:69], v32 offset:40960
ds_read_b64_tr_b16 a[70:71], v32 offset:43008
ds_read_b64_tr_b16 a[72:73], v30 offset:41472
ds_read_b64_tr_b16 a[74:75], v30 offset:43520
buffer_load_dwordx4 v15, s[32:35], s61 offen offset:1024 lds
ds_read_b64_tr_b16 a[76:77], v32 offset:41472
ds_read_b64_tr_b16 a[78:79], v32 offset:43520
s_buffer_load_dwordx2 s[0:1], s[48:51], s11 offset:0
ds_read_b64_tr_b16 a[80:81], v30 offset:41984
ds_read_b64_tr_b16 a[82:83], v30 offset:44032
ds_read_b64_tr_b16 a[84:85], v32 offset:41984
ds_read_b64_tr_b16 a[86:87], v32 offset:44032
ds_read_b64_tr_b16 a[88:89], v30 offset:42496
ds_read_b64_tr_b16 a[90:91], v30 offset:44544
s_add_u32 m0, s60, 131072
s_mov_b32 s61, 1032192
buffer_load_dwordx4 v14, s[32:35], s61 offen lds
ds_read_b64_tr_b16 a[92:93], v32 offset:42496
ds_read_b64_tr_b16 a[94:95], v32 offset:44544
ds_read_b64_tr_b16 a[96:97], v29 offset:24576
ds_read_b64_tr_b16 a[98:99], v29 offset:26624
ds_read_b64_tr_b16 a[100:101], v31 offset:24576
ds_read_b64_tr_b16 a[102:103], v31 offset:26624
ds_read_b64_tr_b16 a[104:105], v29 offset:25088
buffer_load_dwordx4 v15, s[32:35], s61 offen offset:1024 lds
ds_read_b64_tr_b16 a[106:107], v29 offset:27136
ds_read_b64_tr_b16 a[108:109], v31 offset:25088
ds_read_b64_tr_b16 a[110:111], v31 offset:27136
ds_read_b64_tr_b16 a[112:113], v29 offset:25600
ds_read_b64_tr_b16 a[114:115], v29 offset:27648
ds_read_b64_tr_b16 a[116:117], v31 offset:25600
ds_read_b64_tr_b16 a[118:119], v31 offset:27648
s_add_u32 m0, s60, 139264
s_mov_b32 s61, 1146880
buffer_load_dwordx4 v14, s[32:35], s61 offen lds
ds_read_b64_tr_b16 a[120:121], v29 offset:26112
ds_read_b64_tr_b16 a[122:123], v29 offset:28160
ds_read_b64_tr_b16 a[124:125], v31 offset:26112
ds_read_b64_tr_b16 a[126:127], v31 offset:28160
ds_read_b64_tr_b16 a[128:129], v29 offset:32768
ds_read_b64_tr_b16 a[130:131], v29 offset:34816
ds_read_b64_tr_b16 a[132:133], v31 offset:32768
buffer_load_dwordx4 v15, s[32:35], s61 offen offset:1024 lds
ds_read_b64_tr_b16 a[134:135], v31 offset:34816
s_waitcnt lgkmcnt(0)
s_cmp_lg_u64 s[0:1], s[16:17]
s_cbranch_scc1 L_spin0
L_back0:
buffer_load_dwordx4 v[80:83], v64, s[48:51], s5 offen sc1
ds_read_b64_tr_b16 a[136:137], v29 offset:33280
ds_read_b64_tr_b16 a[138:139], v29 offset:35328
ds_read_b64_tr_b16 a[140:141], v31 offset:33280
ds_read_b64_tr_b16 a[142:143], v31 offset:35328
ds_read_b64_tr_b16 a[144:145], v29 offset:33792
buffer_load_dwordx4 v[84:87], v64, s[48:51], s5 offen offset:1024 sc1
ds_read_b64_tr_b16 a[146:147], v29 offset:35840
ds_read_b64_tr_b16 a[148:149], v31 offset:33792
ds_read_b64_tr_b16 a[150:151], v31 offset:35840
ds_read_b64_tr_b16 a[152:153], v29 offset:34304
ds_read_b64_tr_b16 a[154:155], v29 offset:36352
buffer_load_dwordx4 v[88:91], v64, s[48:51], s6 offen sc1
ds_read_b64_tr_b16 a[156:157], v31 offset:34304
ds_read_b64_tr_b16 a[158:159], v31 offset:36352
ds_read_b64_tr_b16 a[160:161], v29 offset:40960
ds_read_b64_tr_b16 a[162:163], v29 offset:43008
ds_read_b64_tr_b16 a[164:165], v31 offset:40960
buffer_load_dwordx4 v[92:95], v64, s[48:51], s6 offen offset:1024 sc1
ds_read_b64_tr_b16 a[166:167], v31 offset:43008
ds_read_b64_tr_b16 a[168:169], v29 offset:41472
ds_read_b64_tr_b16 a[170:171], v29 offset:43520
ds_read_b64_tr_b16 a[172:173], v31 offset:41472
ds_read_b64_tr_b16 a[174:175], v31 offset:43520
buffer_load_dwordx4 v[96:99], v64, s[48:51], s7 offen sc1
ds_read_b64_tr_b16 a[176:177], v29 offset:41984
ds_read_b64_tr_b16 a[178:179], v29 offset:44032
ds_read_b64_tr_b16 a[180:181], v31 offset:41984
ds_read_b64_tr_b16 a[182:183], v31 offset:44032
v_mfma_f32_16x16x32_bf16 v[128:131], a[0:3], v[72:75], v[128:131]
v_mfma_f32_16x16x32_bf16 v[132:135], a[4:7], v[72:75], v[132:135]
buffer_load_dwordx4 v[100:103], v64, s[48:51], s7 offen offset:1024 sc1
ds_read_b64_tr_b16 a[184:185], v29 offset:42496
ds_read_b64_tr_b16 a[186:187], v29 offset:44544
ds_read_b64_tr_b16 a[188:189], v31 offset:42496
ds_read_b64_tr_b16 a[190:191], v31 offset:44544
ds_read_b64_tr_b16 a[192:193], v29 offset:49152
v_mfma_f32_16x16x32_bf16 v[136:139], a[8:11], v[72:75], v[136:139]
buffer_load_dwordx4 v[104:107], v64, s[48:51], s8 offen sc1
ds_read_b64_tr_b16 a[194:195], v29 offset:51200
ds_read_b64_tr_b16 a[196:197], v31 offset:49152
ds_read_b64_tr_b16 a[198:199], v31 offset:51200
ds_read_b64_tr_b16 a[200:201], v29 offset:49664
ds_read_b64_tr_b16 a[202:203], v29 offset:51712
v_mfma_f32_16x16x32_bf16 v[140:143], a[12:15], v[72:75], v[140:143]
v_mfma_f32_16x16x32_bf16 v[128:131], a[16:19], v[76:79], v[128:131]
buffer_load_dwordx4 v[108:111], v64, s[48:51], s8 offen offset:1024 sc1
ds_read_b64_tr_b16 a[204:205], v31 offset:49664
ds_read_b64_tr_b16 a[206:207], v31 offset:51712
ds_read_b64_tr_b16 a[208:209], v29 offset:50176
ds_read_b64_tr_b16 a[210:211], v29 offset:52224
ds_read_b64_tr_b16 a[212:213], v31 offset:50176
v_mfma_f32_16x16x32_bf16 v[132:135], a[20:23], v[76:79], v[132:135]
buffer_load_dwordx4 v[112:115], v64, s[48:51], s9 offen sc1
ds_read_b64_tr_b16 a[214:215], v31 offset:52224
ds_read_b64_tr_b16 a[216:217], v29 offset:50688
ds_read_b64_tr_b16 a[218:219], v29 offset:52736
ds_read_b64_tr_b16 a[220:221], v31 offset:50688
ds_read_b64_tr_b16 a[222:223], v31 offset:52736
v_mfma_f32_16x16x32_bf16 v[136:139], a[24:27], v[76:79], v[136:139]
v_mfma_f32_16x16x32_bf16 v[140:143], a[28:31], v[76:79], v[140:143]
s_waitcnt vmcnt(9) lgkmcnt(0)
s_barrier
s_waitcnt vmcnt(8)
v_mfma_f32_16x16x32_bf16 v[128:131], a[32:35], v[80:83], v[128:131]
buffer_load_dwordx4 v[116:119], v64, s[48:51], s9 offen offset:1024 sc1
ds_read_b64_tr_b16 v[144:145], v35 offset:8192
v_mfma_f32_16x16x32_bf16 v[132:135], a[36:39], v[80:83], v[132:135]
ds_read_b64_tr_b16 v[146:147], v35 offset:12288
v_mfma_f32_16x16x32_bf16 v[136:139], a[40:43], v[80:83], v[136:139]
ds_read_b64_tr_b16 v[148:149], v35 offset:9216
v_mfma_f32_16x16x32_bf16 v[140:143], a[44:47], v[80:83], v[140:143]
buffer_load_dwordx4 v[120:123], v64, s[48:51], s10 offen sc1
ds_read_b64_tr_b16 v[150:151], v35 offset:13312
s_waitcnt vmcnt(9)
v_mfma_f32_16x16x32_bf16 v[128:131], a[48:51], v[84:87], v[128:131]
ds_read_b64_tr_b16 v[152:153], v33 offset:0
v_mfma_f32_16x16x32_bf16 v[132:135], a[52:55], v[84:87], v[132:135]
ds_read_b64_tr_b16 v[154:155], v33 offset:4096
v_mfma_f32_16x16x32_bf16 v[136:139], a[56:59], v[84:87], v[136:139]
buffer_load_dwordx4 v[124:127], v64, s[48:51], s10 offen offset:1024 sc1
ds_read_b64_tr_b16 v[156:157], v33 offset:1024
v_mfma_f32_16x16x32_bf16 v[140:143], a[60:63], v[84:87], v[140:143]
ds_read_b64_tr_b16 v[158:159], v33 offset:5120
s_waitcnt vmcnt(9)
v_mfma_f32_16x16x32_bf16 v[128:131], a[64:67], v[88:91], v[128:131]
ds_read_b64_tr_b16 v[160:161], v33 offset:8192
v_mfma_f32_16x16x32_bf16 v[132:135], a[68:71], v[88:91], v[132:135]
ds_read_b64_tr_b16 v[162:163], v33 offset:12288
s_add_u32 m0, s60, 40960
s_mov_b32 s61, 1261568
buffer_load_dwordx4 v14, s[32:35], s61 offen lds
v_mfma_f32_16x16x32_bf16 v[136:139], a[72:75], v[88:91], v[136:139]
ds_read_b64_tr_b16 v[164:165], v33 offset:9216
v_mfma_f32_16x16x32_bf16 v[140:143], a[76:79], v[88:91], v[140:143]
s_waitcnt vmcnt(9)
v_mfma_f32_16x16x32_bf16 v[128:131], a[80:83], v[92:95], v[128:131]
ds_read_b64_tr_b16 v[166:167], v33 offset:13312
v_mfma_f32_16x16x32_bf16 v[132:135], a[84:87], v[92:95], v[132:135]
ds_read_b64_tr_b16 v[168:169], v33 offset:16384
buffer_load_dwordx4 v15, s[32:35], s61 offen offset:1024 lds
v_mfma_f32_16x16x32_bf16 v[136:139], a[88:91], v[92:95], v[136:139]
ds_read_b64_tr_b16 v[170:171], v33 offset:20480
v_mfma_f32_16x16x32_bf16 v[140:143], a[92:95], v[92:95], v[140:143]
ds_read_b64_tr_b16 v[172:173], v33 offset:17408
s_waitcnt vmcnt(9)
v_mfma_f32_16x16x32_bf16 v[128:131], a[96:99], v[96:99], v[128:131]
ds_read_b64_tr_b16 v[174:175], v33 offset:21504
v_mfma_f32_16x16x32_bf16 v[132:135], a[100:103], v[96:99], v[132:135]
ds_read_b64_tr_b16 v[176:177], v33 offset:24576
v_mfma_f32_16x16x32_bf16 v[136:139], a[104:107], v[96:99], v[136:139]
ds_read_b64_tr_b16 v[178:179], v33 offset:28672
s_add_u32 m0, s60, 65536
s_mov_b32 s61, 1376256
buffer_load_dwordx4 v14, s[32:35], s61 offen lds
v_mfma_f32_16x16x32_bf16 v[140:143], a[108:111], v[96:99], v[140:143]
ds_read_b64_tr_b16 v[180:181], v33 offset:25600
s_waitcnt vmcnt(9)
v_mfma_f32_16x16x32_bf16 v[128:131], a[112:115], v[100:103], v[128:131]
ds_read_b64_tr_b16 v[182:183], v33 offset:29696
v_mfma_f32_16x16x32_bf16 v[132:135], a[116:119], v[100:103], v[132:135]
ds_read_b64_tr_b16 v[184:185], v33 offset:32768
v_mfma_f32_16x16x32_bf16 v[136:139], a[120:123], v[100:103], v[136:139]
ds_read_b64_tr_b16 v[186:187], v33 offset:36864
v_mfma_f32_16x16x32_bf16 v[140:143], a[124:127], v[100:103], v[140:143]
buffer_load_dwordx4 v15, s[32:35], s61 offen offset:1024 lds
s_waitcnt vmcnt(9)
v_mfma_f32_16x16x32_bf16 v[128:131], a[128:131], v[104:107], v[128:131]
ds_read_b64_tr_b16 v[188:189], v33 offset:33792
v_mfma_f32_16x16x32_bf16 v[132:135], a[132:135], v[104:107], v[132:135]
ds_read_b64_tr_b16 v[190:191], v33 offset:37888
v_mfma_f32_16x16x32_bf16 v[136:139], a[136:139], v[104:107], v[136:139]
ds_read_b64_tr_b16 v[192:193], v33 offset:49152
v_mfma_f32_16x16x32_bf16 v[140:143], a[140:143], v[104:107], v[140:143]
ds_read_b64_tr_b16 v[194:195], v33 offset:53248
s_waitcnt vmcnt(8)
v_mfma_f32_16x16x32_bf16 v[128:131], a[144:147], v[108:111], v[128:131]
ds_read_b64_tr_b16 v[196:197], v33 offset:50176
s_add_u32 m0, s60, 73728
s_mov_b32 s61, 1490944
buffer_load_dwordx4 v14, s[32:35], s61 offen lds
v_mfma_f32_16x16x32_bf16 v[132:135], a[148:151], v[108:111], v[132:135]
ds_read_b64_tr_b16 v[198:199], v33 offset:54272
v_mfma_f32_16x16x32_bf16 v[136:139], a[152:155], v[108:111], v[136:139]
ds_read_b64_tr_b16 v[200:201], v34 offset:0
v_mfma_f32_16x16x32_bf16 v[140:143], a[156:159], v[108:111], v[140:143]
ds_read_b64_tr_b16 v[202:203], v34 offset:4096
s_waitcnt vmcnt(8)
v_mfma_f32_16x16x32_bf16 v[128:131], a[160:163], v[112:115], v[128:131]
ds_read_b64_tr_b16 v[204:205], v34 offset:1024
v_mfma_f32_16x16x32_bf16 v[132:135], a[164:167], v[112:115], v[132:135]
ds_read_b64_tr_b16 v[206:207], v34 offset:5120
buffer_load_dwordx4 v15, s[32:35], s61 offen offset:1024 lds
v_mfma_f32_16x16x32_bf16 v[136:139], a[168:171], v[112:115], v[136:139]
ds_read_b64_tr_b16 v[208:209], v35 offset:0
v_mfma_f32_16x16x32_bf16 v[140:143], a[172:175], v[112:115], v[140:143]
s_waitcnt vmcnt(8)
v_mfma_f32_16x16x32_bf16 v[128:131], a[176:179], v[116:119], v[128:131]
ds_read_b64_tr_b16 v[210:211], v35 offset:4096
v_mfma_f32_16x16x32_bf16 v[132:135], a[180:183], v[116:119], v[132:135]
ds_read_b64_tr_b16 v[212:213], v35 offset:1024
v_mfma_f32_16x16x32_bf16 v[136:139], a[184:187], v[116:119], v[136:139]
s_add_u32 m0, s60, 155648
ds_read_b64_tr_b16 v[214:215], v35 offset:5120
buffer_load_dwordx4 v8, s[36:39], s69 offen lds
v_mfma_f32_16x16x32_bf16 v[140:143], a[188:191], v[116:119], v[140:143]
ds_read_b64_tr_b16 v[216:217], v35 offset:16384
s_waitcnt vmcnt(8)
v_mfma_f32_16x16x32_bf16 v[128:131], a[192:195], v[120:123], v[128:131]
ds_read_b64_tr_b16 v[218:219], v35 offset:20480
v_mfma_f32_16x16x32_bf16 v[132:135], a[196:199], v[120:123], v[132:135]
ds_read_b64_tr_b16 v[220:221], v35 offset:17408
v_mfma_f32_16x16x32_bf16 v[136:139], a[200:203], v[120:123], v[136:139]
ds_read_b64_tr_b16 v[222:223], v35 offset:21504
v_mfma_f32_16x16x32_bf16 v[140:143], a[204:207], v[120:123], v[140:143]
ds_read_b64_tr_b16 v[224:225], v35 offset:24576
buffer_load_dwordx4 v9, s[36:39], s69 offen offset:1024 lds
s_waitcnt vmcnt(8)
v_mfma_f32_16x16x32_bf16 v[128:131], a[208:211], v[124:127], v[128:131]
ds_read_b64_tr_b16 v[226:227], v35 offset:28672
v_mfma_f32_16x16x32_bf16 v[132:135], a[212:215], v[124:127], v[132:135]
ds_read_b64_tr_b16 v[228:229], v35 offset:25600
v_mfma_f32_16x16x32_bf16 v[136:139], a[216:219], v[124:127], v[136:139]
ds_read_b64_tr_b16 v[230:231], v35 offset:29696
v_mfma_f32_16x16x32_bf16 v[140:143], a[220:223], v[124:127], v[140:143]
s_nop 1
v_cvt_pk_bf16_f32 v64, v128, v129
v_cvt_pk_bf16_f32 v65, v130, v131
v_cvt_pk_bf16_f32 v66, v132, v133
v_cvt_pk_bf16_f32 v67, v134, v135
v_cvt_pk_bf16_f32 v68, v136, v137
v_cvt_pk_bf16_f32 v69, v138, v139
v_cvt_pk_bf16_f32 v70, v140, v141
v_cvt_pk_bf16_f32 v71, v142, v143
v_permlane32_swap_b32 v64, v66
v_permlane32_swap_b32 v65, v67
v_permlane32_swap_b32 v68, v70
v_permlane32_swap_b32 v69, v71
buffer_store_dwordx4 v[64:67], v36, s[48:51], s26 offen sc1
buffer_store_dwordx4 v[68:71], v36, s[48:51], s26 offen offset:2048 sc1
v_dot2c_f32_bf16 v38, v20, v64
v_dot2c_f32_bf16 v39, v64, v64
v_dot2c_f32_bf16 v38, v20, v65
v_dot2c_f32_bf16 v39, v65, v65
v_dot2c_f32_bf16 v38, v20, v66
v_dot2c_f32_bf16 v39, v66, v66
v_dot2c_f32_bf16 v38, v20, v67
v_dot2c_f32_bf16 v39, v67, v67
v_dot2c_f32_bf16 v38, v20, v68
v_dot2c_f32_bf16 v39, v68, v68
v_dot2c_f32_bf16 v38, v20, v69
v_dot2c_f32_bf16 v39, v69, v69
v_dot2c_f32_bf16 v38, v20, v70
v_dot2c_f32_bf16 v39, v70, v70
v_dot2c_f32_bf16 v38, v20, v71
v_dot2c_f32_bf16 v39, v71, v71
s_nop 2
v_permlane32_swap_b32 v38, v39
v_add_f32 v38, v38, v39
v_mov_b32 v39, v38
s_nop 1
v_permlane16_swap_b32 v38, v39
v_add_f32 v38, v38, v39
buffer_store_dword v38, v37, s[48:51], s28 offen sc1
v_lshrrev_b32 v2, 2, v1
v_xor_b32 v2, v2, v17
v_and_b32 v2, 1, v2
v_cmp_eq_u32 vcc, 0, v2
s_nop 1
v_cndmask_b32 v20, 0, v20, vcc
v_cndmask_b32 v21, 0, v21, vcc
v_cndmask_b32 v22, 0, v22, vcc
v_cndmask_b32 v23, 0, v23, vcc
s_waitcnt vmcnt(5) lgkmcnt(0)
s_barrier
v_mfma_f32_16x16x32_bf16 v[112:115], v[20:23], v[144:147], 0
ds_read_b64_tr_b16 v[232:233], v33 offset:40960
ds_read_b64_tr_b16 v[234:235], v33 offset:45056
ds_read_b64_tr_b16 v[236:237], v33 offset:41984
ds_read_b64_tr_b16 v[238:239], v33 offset:46080
v_lshl_add_u32 v2, v6, 8, v19
v_add_u32 v2, s60, v2
v_mfma_f32_16x16x32_bf16 v[112:115], v[20:23], v[148:151], v[112:115]
ds_read_b64_tr_b16 v[240:241], v34 offset:8192
ds_read_b64_tr_b16 v[242:243], v34 offset:12288
ds_read_b64_tr_b16 v[244:245], v34 offset:9216
ds_read_b64_tr_b16 v[246:247], v34 offset:13312
v_mov_b32 v12, v2
v_add_u32 v13, 114688, v2
s_lshl_b32 s26, s52, 10
v_mfma_f32_16x16x32_bf16 v[112:115], v[20:23], v[152:155], v[112:115]
ds_read_b64_tr_b16 v[248:249], v34 offset:16384
ds_read_b64_tr_b16 v[250:251], v34 offset:20480
ds_read_b64_tr_b16 v[252:253], v34 offset:17408
ds_read_b64_tr_b16 v[254:255], v34 offset:21504
s_mul_i32 s58, s54, 163840
s_add_u32 s59, s25, s58
s_add_u32 s28, s59, s60
v_mfma_f32_16x16x32_bf16 v[112:115], v[20:23], v[156:159], v[112:115]
s_waitcnt vmcnt(3)
ds_read_b64_tr_b16 a[16:17], v13 offset:40960
s_add_u32 s30, s59, s26
s_sub_u32 s58, 163840, s58
s_add_u32 s59, s25, s58
v_mfma_f32_16x16x32_bf16 v[112:115], v[20:23], v[160:163], v[112:115]
ds_read_b64_tr_b16 a[18:19], v13 offset:41984
s_add_u32 s29, s59, s60
s_add_u32 s31, s59, s26
v_lshl_add_u32 v37, v18, 7, v37
v_mfma_f32_16x16x32_bf16 v[112:115], v[20:23], v[164:167], v[112:115]
ds_read_b64_tr_b16 a[20:21], v13 offset:41472
v_add_u32 v29, 229376, v5
v_add_u32 v30, 57344, v5
v_add_u32 v31, s20, v5
v_mfma_f32_16x16x32_bf16 v[112:115], v[20:23], v[168:171], v[112:115]
ds_read_b64_tr_b16 a[22:23], v13 offset:42496
s_lshl_b32 s58, s54, 1
s_xor_b32 s58, s58, 2
s_xor_b32 s58, s58, s52
v_mfma_f32_16x16x32_bf16 v[112:115], v[20:23], v[172:175], v[112:115]
s_mul_i32 s58, s58, 81920
s_add_u32 s27, s27, s58
v_and_b32 v2, 31, v1
s_waitcnt vmcnt(0) lgkmcnt(0)
s_barrier
buffer_store_byte v25, v24, s[48:51], s12 offen offset:2048
s_add_u32 m0, s60, 38912
v_mfma_f32_16x16x32_bf16 v[112:115], v[20:23], v[176:179], v[112:115]
buffer_load_dwordx4 v10, s[36:39], s69 offen offset:2048 lds
v_mul_u32_u24 v41, 896, v2
v_lshl_add_u32 v41, v6, 4, v41
v_lshlrev_b32 v2, 3, v2
v_mfma_f32_16x16x32_bf16 v[112:115], v[20:23], v[180:183], v[112:115]
v_add_u32 v32, 162816, v2
s_lshl_b32 s58, s52, 8
v_add_u32 v36, s58, v32
v_mfma_f32_16x16x32_bf16 v[112:115], v[20:23], v[184:187], v[112:115]
s_lshl2_add_u32 s58, s55, s52
s_lshl_b32 s59, s58, 10
v_add_u32 v40, s59, v30
v_mfma_f32_16x16x32_bf16 v[112:115], v[20:23], v[188:191], v[112:115]
s_mul_i32 s44, s57, 896
s_lshl_b32 s58, s58, 5
s_add_u32 s44, s44, s58
v_mfma_f32_16x16x32_bf16 v[112:115], v[20:23], v[192:195], v[112:115]
buffer_load_dwordx4 v11, s[36:39], s69 offen offset:3072 lds
v_mfma_f32_16x16x32_bf16 v[112:115], v[20:23], v[196:199], v[112:115]
v_mfma_f32_16x16x32_bf16 v[112:115], v[20:23], v[200:203], v[112:115]
v_mfma_f32_16x16x32_bf16 v[112:115], v[20:23], v[204:207], v[112:115]
v_mfma_f32_16x16x32_bf16 v[112:115], v[20:23], v[208:211], v[112:115]
s_buffer_load_dwordx4 s[0:3], s[48:51], s90 offset:2048
s_add_u32 m0, s60, 49152
s_nop 0
buffer_load_dwordx4 v8, s[36:39], s70 offen lds
v_mfma_f32_16x16x32_bf16 v[112:115], v[20:23], v[212:215], v[112:115]
v_mfma_f32_16x16x32_bf16 v[112:115], v[20:23], v[216:219], v[112:115]
v_mfma_f32_16x16x32_bf16 v[112:115], v[20:23], v[220:223], v[112:115]
v_mfma_f32_16x16x32_bf16 v[112:115], v[20:23], v[224:227], v[112:115]
v_mfma_f32_16x16x32_bf16 v[112:115], v[20:23], v[228:231], v[112:115]
v_mfma_f32_16x16x32_bf16 v[112:115], v[20:23], v[232:235], v[112:115]
buffer_load_dwordx4 v9, s[36:39], s70 offen offset:1024 lds
v_mfma_f32_16x16x32_bf16 v[112:115], v[20:23], v[236:239], v[112:115]
v_mfma_f32_16x16x32_bf16 v[112:115], v[20:23], v[240:243], v[112:115]
v_mfma_f32_16x16x32_bf16 v[112:115], v[20:23], v[244:247], v[112:115]
v_mfma_f32_16x16x32_bf16 v[112:115], v[20:23], v[248:251], v[112:115]
v_mfma_f32_16x16x32_bf16 v[112:115], v[20:23], v[252:255], v[112:115]
s_waitcnt lgkmcnt(0)
s_xor_b64 s[0:1], s[0:1], s[16:17]
s_xor_b64 s[2:3], s[2:3], s[16:17]
s_or_b64 s[0:1], s[0:1], s[2:3]
s_cbranch_scc1 L_spin1
L_back1:
s_barrier
s_add_u32 m0, s60, 0
s_add_u32 s61, s29, 0
buffer_load_dwordx4 v5, s[48:51], s61 offen sc1 lds
buffer_load_dwordx4 v5, s[48:51], s61 offen offset:1024 sc1 lds
s_add_u32 m0, s60, 8192
s_add_u32 s61, s29, 16384
buffer_load_dwordx4 v5, s[48:51], s61 offen sc1 lds
buffer_load_dwordx4 v5, s[48:51], s61 offen offset:1024 sc1 lds
s_waitcnt vmcnt(6)
ds_read_b64_tr_b16 a[24:25], v12 offset:40960
s_add_u32 m0, s60, 16384
s_add_u32 s61, s29, 32768
buffer_load_dwordx4 v5, s[48:51], s61 offen sc1 lds
ds_read_b64_tr_b16 a[26:27], v12 offset:41984
buffer_load_dwordx4 v5, s[48:51], s61 offen offset:1024 sc1 lds
ds_read_b64_tr_b16 a[28:29], v12 offset:41472
s_add_u32 m0, s26, 24576
s_add_u32 s61, s31, 49152
buffer_load_dwordx4 v5, s[48:51], s61 offen sc1 lds
ds_read_b64_tr_b16 a[30:31], v12 offset:42496
s_add_u32 m0, s60, 28672
s_add_u32 s61, s29, 81920
buffer_load_dwordx4 v5, s[48:51], s61 offen sc1 lds
s_waitcnt vmcnt(8)
ds_read_b64_tr_b16 a[32:33], v12 offset:49152
buffer_load_dwordx4 v5, s[48:51], s61 offen offset:1024 sc1 lds
ds_read_b64_tr_b16 a[34:35], v12 offset:50176
ds_read_b64_tr_b16 a[36:37], v12 offset:49664
buffer_load_dword v56, v37, s[48:51], s27 offen sc1
ds_read_b64_tr_b16 a[38:39], v12 offset:50688
s_waitcnt vmcnt(8) lgkmcnt(0)
s_barrier
ds_read_b128 v[64:67], v5 offset:0
ds_read_b128 v[68:71], v5 offset:1024
ds_read_b128 v[72:75], v5 offset:2048
ds_read_b128 v[76:79], v5 offset:3072
ds_read_b128 v[80:83], v5 offset:4096
ds_read_b128 v[84:87], v5 offset:5120
s_waitcnt lgkmcnt(5)
v_mfma_f32_32x32x16_bf16 v[96:111], v[144:147], v[64:67], 0
ds_read_b128 v[88:91], v5 offset:6144
ds_read_b128 v[92:95], v5 offset:7168
buffer_load_dword v57, v37, s[48:51], s27 offen offset:256 sc1
s_waitcnt lgkmcnt(6)
v_mfma_f32_32x32x16_bf16 v[96:111], v[148:151], v[68:71], v[96:111]
buffer_load_dword v58, v37, s[48:51], s27 offen offset:512 sc1
s_waitcnt vmcnt(8)
s_barrier
s_waitcnt lgkmcnt(5)
v_mfma_f32_32x32x16_bf16 v[96:111], v[152:155], v[72:75], v[96:111]
ds_read_b128 v[64:67], v5 offset:8192
ds_read_b128 v[68:71], v5 offset:9216
buffer_load_dword v59, v37, s[48:51], s27 offen offset:768 sc1
s_waitcnt lgkmcnt(6)
v_mfma_f32_32x32x16_bf16 v[96:111], v[156:159], v[76:79], v[96:111]
s_waitcnt lgkmcnt(2)
v_mfma_f32_32x32x16_bf16 v[96:111], v[160:163], v[80:83], v[96:111]
ds_read_b128 v[72:75], v5 offset:10240
ds_read_b128 v[76:79], v5 offset:11264
buffer_load_dword v60, v37, s[48:51], s27 offen offset:1024 sc1
v_cvt_pk_bf16_f32 v128, v112, v112
v_and_b32 v129, 0xffff0000, v128
v_mfma_f32_32x32x16_bf16 v[96:111], v[164:167], v[84:87], v[96:111]
buffer_load_dword v61, v37, s[48:51], s27 offen offset:1280 sc1
v_sub_f32 v129, v112, v129
v_cvt_pk_bf16_f32 v129, v129, v129
v_mfma_f32_32x32x16_bf16 v[96:111], v[168:171], v[88:91], v[96:111]
ds_read_b128 v[80:83], v5 offset:12288
ds_read_b128 v[84:87], v5 offset:13312
v_cmp_gt_u32 vcc, 32, v1
v_mov_b32 v130, 0
v_mfma_f32_32x32x16_bf16 v[96:111], v[172:175], v[92:95], v[96:111]
buffer_load_dword v62, v37, s[48:51], s27 offen offset:1536 sc1
v_mov_b32 v131, 0
v_cndmask_b32 v128, v129, v128, vcc
s_waitcnt lgkmcnt(2)
v_mfma_f32_32x32x16_bf16 v[96:111], v[176:179], v[64:67], v[96:111]
ds_read_b128 v[88:91], v5 offset:14336
ds_read_b128 v[92:95], v5 offset:15360
s_add_u32 m0, s60, 36864
s_add_u32 s61, s29, 98304
buffer_load_dwordx4 v5, s[48:51], s61 offen sc1 lds
v_mov_b32 v129, 0
v_mov_b32 v133, 0
v_mfma_f32_32x32x16_bf16 v[96:111], v[180:183], v[68:71], v[96:111]
v_mov_b32 v134, 0
v_mov_b32 v135, 0
s_waitcnt vmcnt(10)
s_barrier
v_mfma_f32_32x32x16_bf16 v[96:111], v[184:187], v[72:75], v[96:111]
ds_read_b128 v[64:67], v5 offset:16384
ds_read_b128 v[68:71], v5 offset:17408
buffer_load_dwordx4 v5, s[48:51], s61 offen offset:1024 sc1 lds
s_waitcnt vmcnt(7)
v_add_f32 v56, v56, v57
s_waitcnt vmcnt(6)
v_add_f32 v56, v56, v58
v_mfma_f32_32x32x16_bf16 v[96:111], v[188:191], v[76:79], v[96:111]
s_add_u32 m0, s60, 45056
s_add_u32 s61, s29, 114688
buffer_load_dwordx4 v5, s[48:51], s61 offen sc1 lds
s_waitcnt vmcnt(6)
v_add_f32 v56, v56, v59
s_waitcnt lgkmcnt(2)
v_mfma_f32_32x32x16_bf16 v[96:111], v[192:195], v[80:83], v[96:111]
ds_read_b128 v[72:75], v5 offset:18432
ds_read_b128 v[76:79], v5 offset:19456
buffer_load_dwordx4 v5, s[48:51], s61 offen offset:1024 sc1 lds
s_waitcnt vmcnt(6)
v_add_f32 v56, v56, v60
s_waitcnt vmcnt(5)
v_add_f32 v56, v56, v61
v_mfma_f32_32x32x16_bf16 v[96:111], v[196:199], v[84:87], v[96:111]
s_waitcnt vmcnt(4)
v_add_f32 v56, v56, v62
v_mfma_f32_32x32x16_bf16 v[96:111], v[200:203], v[88:91], v[96:111]
ds_read_b128 v[80:83], v5 offset:20480
ds_read_b128 v[84:87], v5 offset:21504
s_add_u32 m0, s26, 53248
s_add_u32 s61, s31, 131072
buffer_load_dwordx4 v5, s[48:51], s61 offen sc1 lds
v_mov_b32 v57, v56
s_nop 1
v_permlane32_swap_b32 v56, v57
v_mfma_f32_32x32x16_bf16 v[96:111], v[204:207], v[92:95], v[96:111]
s_add_u32 m0, s60, 57344
s_add_u32 s61, s28, 0
buffer_load_dwordx4 v5, s[48:51], s61 offen sc1 lds
v_mul_f32 v60, -v56, v56
v_mul_f32 v56, 0xbb124925, v56
s_waitcnt lgkmcnt(2)
v_mfma_f32_32x32x16_bf16 v[96:111], v[208:211], v[64:67], v[96:111]
ds_read_b128 v[88:91], v5 offset:22528
ds_read_b128 v[92:95], v5 offset:23552
v_fmamk_f32 v60, v57, 0x43e00000, v60
v_mfma_f32_32x32x16_bf16 v[96:111], v[212:215], v[68:71], v[96:111]
buffer_load_dwordx4 v5, s[48:51], s61 offen offset:1024 sc1 lds
v_cmp_lt_f32 s[66:67], 0, v60
v_add_f32 v60, 0x40007358, v60
v_mfma_f32_32x32x16_bf16 v[96:111], v[216:219], v[72:75], v[96:111]
ds_read_b128 v[64:67], v5 offset:24576
ds_read_b128 v[68:71], v5 offset:25600
s_add_u32 m0, s60, 65536
s_add_u32 s61, s28, 16384
buffer_load_dwordx4 v5, s[48:51], s61 offen sc1 lds
v_rsq_f32 v60, v60
v_mfma_f32_32x32x16_bf16 v[96:111], v[220:223], v[76:79], v[96:111]
v_mul_f32 v58, 0x4351f6ad, v60
s_waitcnt lgkmcnt(2)
v_mfma_f32_32x32x16_bf16 v[96:111], v[224:227], v[80:83], v[96:111]
ds_read_b128 v[72:75], v5 offset:26624
ds_read_b128 v[76:79], v5 offset:27648
buffer_load_dwordx4 v5, s[48:51], s61 offen offset:1024 sc1 lds
v_cndmask_b32 v58, 0, v58, s[66:67]
v_cvt_pk_bf16_f32 v61, v56, v56
v_mfma_f32_32x32x16_bf16 v[96:111], v[228:231], v[84:87], v[96:111]
s_add_u32 m0, s60, 73728
s_add_u32 s61, s28, 32768
buffer_load_dwordx4 v5, s[48:51], s61 offen sc1 lds
v_and_b32 v61, 0xffff0000, v61
s_waitcnt vmcnt(8)
s_barrier
v_mfma_f32_32x32x16_bf16 v[96:111], v[232:235], v[88:91], v[96:111]
ds_read_b128 v[80:83], v5 offset:28672
ds_read_b128 v[84:87], v5 offset:29696
v_sub_f32 v61, v56, v61
v_cvt_pk_bf16_f32 v59, v56, v61
v_mfma_f32_32x32x16_bf16 v[96:111], v[236:239], v[92:95], v[96:111]
ds_write_b64 v36, v[58:59]
buffer_load_dwordx4 v5, s[48:51], s61 offen offset:1024 sc1 lds
s_waitcnt lgkmcnt(3)
v_mfma_f32_32x32x16_bf16 v[96:111], v[240:243], v[64:67], v[96:111]
ds_read_b128 v[88:91], v5 offset:30720
ds_read_b128 v[92:95], v5 offset:31744
s_add_u32 m0, s26, 81920
s_add_u32 s61, s30, 49152
buffer_load_dwordx4 v5, s[48:51], s61 offen sc1 lds
v_mfma_f32_32x32x16_bf16 v[96:111], v[244:247], v[68:71], v[96:111]
s_add_u32 m0, s60, 86016
s_add_u32 s61, s28, 81920
buffer_load_dwordx4 v5, s[48:51], s61 offen sc1 lds
v_mfma_f32_32x32x16_bf16 v[96:111], v[248:251], v[72:75], v[96:111]
ds_read_b128 v[64:67], v5 offset:32768
ds_read_b128 v[68:71], v5 offset:33792
v_mfma_f32_32x32x16_bf16 v[96:111], v[252:255], v[76:79], v[96:111]
buffer_load_dwordx4 v5, s[48:51], s61 offen offset:1024 sc1 lds
s_waitcnt vmcnt(9) lgkmcnt(4)
s_barrier
s_waitcnt lgkmcnt(2)
v_mfma_f32_32x32x16_bf16 v[112:127], v[144:147], v[80:83], 0
ds_read_b128 v[72:75], v5 offset:34816
ds_read_b128 v[76:79], v5 offset:35840
s_add_u32 m0, s60, 94208
s_add_u32 s61, s28, 98304
buffer_load_dwordx4 v5, s[48:51], s61 offen sc1 lds
ds_read_b64 v[16:17], v32 offset:0
ds_read_b64 v[18:19], v32 offset:256
s_waitcnt lgkmcnt(1)
v_mov_b32 v132, v17
v_mfma_f32_32x32x16_bf16 v[112:127], v[148:151], v[84:87], v[112:127]
s_nop 0
v_mfma_f32_32x32x16_bf16 v[96:111], v[128:131], v[132:135], v[96:111]
v_mfma_f32_32x32x16_bf16 v[112:127], v[152:155], v[88:91], v[112:127]
ds_read_b128 v[80:83], v5 offset:36864
ds_read_b128 v[84:87], v5 offset:37888
buffer_load_dwordx4 v5, s[48:51], s61 offen offset:1024 sc1 lds
ds_read_b64 v[20:21], v32 offset:512
ds_read_b64 v[22:23], v32 offset:768
v_mfma_f32_32x32x16_bf16 v[112:127], v[156:159], v[92:95], v[112:127]
s_add_u32 m0, s60, 102400
s_add_u32 s61, s28, 114688
buffer_load_dwordx4 v5, s[48:51], s61 offen sc1 lds
v_mfma_f32_32x32x16_bf16 v[112:127], v[160:163], v[64:67], v[112:127]
ds_read_b128 v[88:91], v5 offset:38912
ds_read_b128 v[92:95], v5 offset:39936
v_mul_f32 v136, v96, v16
v_mul_f32 v137, v97, v16
v_mul_f32 v138, v98, v16
v_mul_f32 v139, v99, v16
v_fma_f32 v6, -v136, v136, -s84
v_fma_f32 v7, -v137, v137, -s84
v_mfma_f32_32x32x16_bf16 v[112:127], v[164:167], v[68:71], v[112:127]
buffer_load_dwordx4 v5, s[48:51], s61 offen offset:1024 sc1 lds
v_fma_f32 v14, -v138, v138, -s84
v_fma_f32 v15, -v139, v139, -s84
v_mul_f32 v6, v136, v6
v_mul_f32 v7, v137, v7
v_mul_f32 v14, v138, v14
s_waitcnt lgkmcnt(6)
v_mov_b32 v132, v19
v_mfma_f32_32x32x16_bf16 v[112:127], v[168:171], v[72:75], v[112:127]
ds_read_b128 v[64:67], v5 offset:40960
ds_read_b128 v[68:71], v5 offset:41984
s_add_u32 m0, s26, 110592
s_add_u32 s61, s30, 131072
buffer_load_dwordx4 v5, s[48:51], s61 offen sc1 lds
v_mul_f32 v15, v139, v15
v_mfma_f32_32x32x16_bf16 v[112:127], v[128:131], v[132:135], v[112:127]
v_exp_f32 v6, v6
v_exp_f32 v7, v7
v_exp_f32 v14, v14
v_exp_f32 v15, v15
v_fma_f32 v6, v6, s82, s82
v_fma_f32 v7, v7, s82, s82
v_mfma_f32_32x32x16_bf16 v[112:127], v[172:175], v[76:79], v[112:127]
v_fma_f32 v14, v14, s82, s82
v_fma_f32 v15, v15, s82, s82
v_rcp_f32 v6, v6
v_rcp_f32 v7, v7
s_waitcnt lgkmcnt(2)
v_mfma_f32_32x32x16_bf16 v[112:127], v[176:179], v[80:83], v[112:127]
ds_read_b128 v[72:75], v5 offset:43008
s_add_u32 m0, s60, 6144
ds_read_b128 v[76:79], v5 offset:44032
buffer_load_dwordx4 v10, s[36:39], s70 offen offset:2048 lds
v_rcp_f32 v14, v14
v_rcp_f32 v15, v15
v_mul_f32 v136, v136, v6
v_mfma_f32_32x32x16_bf16 v[112:127], v[180:183], v[84:87], v[112:127]
v_mul_f32 v137, v137, v7
v_mul_f32 v138, v138, v14
v_mul_f32 v139, v139, v15
v_cvt_pk_bf16_f32 v48, v136, v137
v_cvt_pk_bf16_f32 v49, v138, v139
v_mul_f32 v136, v100, v16
v_mfma_f32_32x32x16_bf16 v[112:127], v[184:187], v[88:91], v[112:127]
ds_read_b128 v[80:83], v5 offset:45056
ds_read_b128 v[84:87], v5 offset:46080
buffer_load_dwordx4 v11, s[36:39], s70 offen offset:3072 lds
v_mul_f32 v137, v101, v16
v_mul_f32 v138, v102, v16
v_mul_f32 v139, v103, v16
v_fma_f32 v6, -v136, v136, -s84
v_fma_f32 v7, -v137, v137, -s84
v_mfma_f32_32x32x16_bf16 v[112:127], v[188:191], v[92:95], v[112:127]
v_fma_f32 v14, -v138, v138, -s84
v_fma_f32 v15, -v139, v139, -s84
v_mul_f32 v6, v136, v6
v_mul_f32 v7, v137, v7
v_mul_f32 v14, v138, v14
v_mul_f32 v15, v139, v15
s_waitcnt lgkmcnt(2)
v_mfma_f32_32x32x16_bf16 v[112:127], v[192:195], v[64:67], v[112:127]
ds_read_b128 v[88:91], v5 offset:47104
ds_read_b128 v[92:95], v5 offset:48128
v_exp_f32 v6, v6
v_exp_f32 v7, v7
v_exp_f32 v14, v14
s_add_u32 m0, s60, 0
v_mfma_f32_32x32x16_bf16 v[112:127], v[196:199], v[68:71], v[112:127]
buffer_load_dwordx4 v8, s[36:39], s68 offen lds
v_exp_f32 v15, v15
v_fma_f32 v6, v6, s82, s82
v_fma_f32 v7, v7, s82, s82
v_fma_f32 v14, v14, s82, s82
v_mfma_f32_32x32x16_bf16 v[112:127], v[200:203], v[72:75], v[112:127]
ds_read_b128 v[64:67], v5 offset:49152
ds_read_b128 v[68:71], v5 offset:50176
v_fma_f32 v15, v15, s82, s82
v_rcp_f32 v6, v6
v_rcp_f32 v7, v7
v_mfma_f32_32x32x16_bf16 v[112:127], v[204:207], v[76:79], v[112:127]
v_rcp_f32 v14, v14
v_rcp_f32 v15, v15
v_mul_f32 v136, v136, v6
v_mul_f32 v137, v137, v7
v_mul_f32 v138, v138, v14
s_waitcnt lgkmcnt(2)
v_mfma_f32_32x32x16_bf16 v[112:127], v[208:211], v[80:83], v[112:127]
ds_read_b128 v[72:75], v5 offset:51200
ds_read_b128 v[76:79], v5 offset:52224
buffer_load_dwordx4 v9, s[36:39], s68 offen offset:1024 lds
v_mul_f32 v139, v139, v15
v_cvt_pk_bf16_f32 v50, v136, v137
v_cvt_pk_bf16_f32 v51, v138, v139
v_mul_f32 v136, v104, v16
v_mul_f32 v137, v105, v16
v_mfma_f32_32x32x16_bf16 v[112:127], v[212:215], v[84:87], v[112:127]
buffer_store_dwordx4 v[48:51], v5, s[48:51], s18 offen sc1
v_mul_f32 v138, v106, v16
v_mul_f32 v139, v107, v16
v_fma_f32 v6, -v136, v136, -s84
v_fma_f32 v7, -v137, v137, -s84
v_fma_f32 v14, -v138, v138, -s84
v_fma_f32 v15, -v139, v139, -s84
v_mfma_f32_32x32x16_bf16 v[112:127], v[216:219], v[88:91], v[112:127]
ds_read_b128 v[80:83], v5 offset:53248
ds_read_b128 v[84:87], v5 offset:54272
v_mul_f32 v6, v136, v6
v_mul_f32 v7, v137, v7
v_mul_f32 v14, v138, v14
v_mul_f32 v15, v139, v15
v_exp_f32 v6, v6
s_add_u32 m0, s60, 14336
v_mfma_f32_32x32x16_bf16 v[112:127], v[220:223], v[92:95], v[112:127]
buffer_load_dwordx4 v10, s[36:39], s68 offen offset:2048 lds
v_exp_f32 v7, v7
v_exp_f32 v14, v14
v_exp_f32 v15, v15
s_waitcnt lgkmcnt(2)
v_mfma_f32_32x32x16_bf16 v[112:127], v[224:227], v[64:67], v[112:127]
ds_read_b128 v[88:91], v5 offset:55296
ds_read_b128 v[92:95], v5 offset:56320
v_fma_f32 v6, v6, s82, s82
v_fma_f32 v7, v7, s82, s82
v_fma_f32 v14, v14, s82, s82
v_fma_f32 v15, v15, s82, s82
v_mfma_f32_32x32x16_bf16 v[112:127], v[228:231], v[68:71], v[112:127]
v_rcp_f32 v6, v6
v_rcp_f32 v7, v7
v_rcp_f32 v14, v14
s_waitcnt vmcnt(13)
s_barrier
v_mfma_f32_32x32x16_bf16 v[112:127], v[232:235], v[72:75], v[112:127]
ds_read_b128 v[64:67], v30 offset:0
ds_read_b128 v[68:71], v30 offset:1024
buffer_load_dwordx4 v11, s[36:39], s68 offen offset:3072 lds
v_rcp_f32 v15, v15
v_mul_f32 v136, v136, v6
v_mul_f32 v137, v137, v7
v_mul_f32 v138, v138, v14
v_mul_f32 v139, v139, v15
v_mfma_f32_32x32x16_bf16 v[112:127], v[236:239], v[76:79], v[112:127]
v_cvt_pk_bf16_f32 v52, v136, v137
v_cvt_pk_bf16_f32 v53, v138, v139
v_mul_f32 v136, v108, v16
v_mul_f32 v137, v109, v16
v_mul_f32 v138, v110, v16
v_mul_f32 v139, v111, v16
s_waitcnt lgkmcnt(2)
v_mfma_f32_32x32x16_bf16 v[112:127], v[240:243], v[80:83], v[112:127]
ds_read_b128 v[72:75], v30 offset:2048
s_add_u32 m0, s60, 24576
ds_read_b128 v[76:79], v30 offset:3072
buffer_load_dwordx4 v8, s[36:39], s71 offen lds
v_fma_f32 v6, -v136, v136, -s84
v_fma_f32 v7, -v137, v137, -s84
v_fma_f32 v14, -v138, v138, -s84
v_fma_f32 v15, -v139, v139, -s84
v_mul_f32 v6, v136, v6
v_mul_f32 v7, v137, v7
v_mfma_f32_32x32x16_bf16 v[112:127], v[244:247], v[84:87], v[112:127]
v_mul_f32 v14, v138, v14
v_mul_f32 v15, v139, v15
v_exp_f32 v6, v6
v_exp_f32 v7, v7
v_mfma_f32_32x32x16_bf16 v[112:127], v[248:251], v[88:91], v[112:127]
ds_read_b128 v[80:83], v30 offset:4096
ds_read_b128 v[84:87], v30 offset:5120
v_exp_f32 v14, v14
v_exp_f32 v15, v15
v_fma_f32 v6, v6, s82, s82
v_mfma_f32_32x32x16_bf16 v[112:127], v[252:255], v[92:95], v[112:127]
buffer_load_dwordx4 v9, s[36:39], s71 offen offset:1024 lds
v_fma_f32 v7, v7, s82, s82
v_fma_f32 v14, v14, s82, s82
v_fma_f32 v15, v15, s82, s82
v_rcp_f32 v6, v6
s_waitcnt lgkmcnt(2)
v_mfma_f32_32x32x16_bf16 v[96:111], v[144:147], v[64:67], 0
ds_read_b128 v[88:91], v30 offset:6144
ds_read_b128 v[92:95], v30 offset:7168
v_rcp_f32 v7, v7
v_rcp_f32 v14, v14
v_rcp_f32 v15, v15
v_mfma_f32_32x32x16_bf16 v[96:111], v[148:151], v[68:71], v[96:111]
v_mul_f32 v136, v136, v6
v_mul_f32 v137, v137, v7
v_mul_f32 v138, v138, v14
v_mul_f32 v139, v139, v15
v_cvt_pk_bf16_f32 v54, v136, v137
v_cvt_pk_bf16_f32 v55, v138, v139
v_mov_b32 v132, v21
v_mfma_f32_32x32x16_bf16 v[96:111], v[152:155], v[72:75], v[96:111]
ds_read_b128 v[64:67], v30 offset:8192
s_add_u32 m0, s60, 30720
ds_read_b128 v[68:71], v30 offset:9216
buffer_load_dwordx4 v10, s[36:39], s71 offen offset:2048 lds
buffer_store_dwordx4 v[52:55], v5, s[48:51], s18 offen offset:1024 sc1
v_mul_f32 v136, v112, v18
v_mul_f32 v137, v113, v18
v_mfma_f32_32x32x16_bf16 v[96:111], v[128:131], v[132:135], v[96:111]
v_mul_f32 v138, v114, v18
v_mul_f32 v139, v115, v18
v_fma_f32 v6, -v136, v136, -s84
v_fma_f32 v7, -v137, v137, -s84
v_fma_f32 v14, -v138, v138, -s84
v_fma_f32 v15, -v139, v139, -s84
v_mul_f32 v6, v136, v6
v_mul_f32 v7, v137, v7
v_mfma_f32_32x32x16_bf16 v[96:111], v[156:159], v[76:79], v[96:111]
v_mul_f32 v14, v138, v14
v_mul_f32 v15, v139, v15
v_exp_f32 v6, v6
v_exp_f32 v7, v7
s_waitcnt lgkmcnt(2)
v_mfma_f32_32x32x16_bf16 v[96:111], v[160:163], v[80:83], v[96:111]
ds_read_b128 v[72:75], v30 offset:10240
ds_read_b128 v[76:79], v30 offset:11264
v_exp_f32 v14, v14
v_exp_f32 v15, v15
v_fma_f32 v6, v6, s82, s82
v_mfma_f32_32x32x16_bf16 v[96:111], v[164:167], v[84:87], v[96:111]
buffer_load_dwordx4 v11, s[36:39], s71 offen offset:3072 lds
v_fma_f32 v7, v7, s82, s82
v_fma_f32 v14, v14, s82, s82
v_fma_f32 v15, v15, s82, s82
v_rcp_f32 v6, v6
v_mfma_f32_32x32x16_bf16 v[96:111], v[168:171], v[88:91], v[96:111]
ds_read_b128 v[80:83], v30 offset:12288
ds_read_b128 v[84:87], v30 offset:13312
v_rcp_f32 v7, v7
v_rcp_f32 v14, v14
v_rcp_f32 v15, v15
v_mfma_f32_32x32x16_bf16 v[96:111], v[172:175], v[92:95], v[96:111]
v_mul_f32 v136, v136, v6
v_mul_f32 v137, v137, v7
v_mul_f32 v138, v138, v14
v_mul_f32 v139, v139, v15
v_cvt_pk_bf16_f32 v56, v136, v137
s_waitcnt lgkmcnt(2)
v_mfma_f32_32x32x16_bf16 v[96:111], v[176:179], v[64:67], v[96:111]
ds_read_b128 v[88:91], v30 offset:14336
s_add_u32 m0, s60, 40960
ds_read_b128 v[92:95], v30 offset:15360
buffer_load_dwordx4 v8, s[36:39], s72 offen lds
v_cvt_pk_bf16_f32 v57, v138, v139
v_mul_f32 v136, v116, v18
v_mul_f32 v137, v117, v18
v_mul_f32 v138, v118, v18
v_mul_f32 v139, v119, v18
v_fma_f32 v6, -v136, v136, -s84
v_mfma_f32_32x32x16_bf16 v[96:111], v[180:183], v[68:71], v[96:111]
v_fma_f32 v7, -v137, v137, -s84
v_fma_f32 v14, -v138, v138, -s84
v_fma_f32 v15, -v139, v139, -s84
v_mul_f32 v6, v136, v6
v_mul_f32 v7, v137, v7
v_mfma_f32_32x32x16_bf16 v[96:111], v[184:187], v[72:75], v[96:111]
ds_read_b128 v[64:67], v30 offset:16384
ds_read_b128 v[68:71], v30 offset:17408
v_mul_f32 v14, v138, v14
v_mul_f32 v15, v139, v15
v_exp_f32 v6, v6
v_exp_f32 v7, v7
v_mfma_f32_32x32x16_bf16 v[96:111], v[188:191], v[76:79], v[96:111]
buffer_load_dwordx4 v9, s[36:39], s72 offen offset:1024 lds
v_exp_f32 v14, v14
v_exp_f32 v15, v15
v_fma_f32 v6, v6, s82, s82
s_waitcnt lgkmcnt(2)
v_mfma_f32_32x32x16_bf16 v[96:111], v[192:195], v[80:83], v[96:111]
ds_read_b128 v[72:75], v30 offset:18432
ds_read_b128 v[76:79], v30 offset:19456
v_fma_f32 v7, v7, s82, s82
v_fma_f32 v14, v14, s82, s82
v_fma_f32 v15, v15, s82, s82
v_rcp_f32 v6, v6
v_mfma_f32_32x32x16_bf16 v[96:111], v[196:199], v[84:87], v[96:111]
s_add_u32 m0, s60, 112640
ds_read_b128 a[224:227], v40 offset:0
buffer_load_dwordx4 v10, s[36:39], s72 offen offset:2048 lds
v_rcp_f32 v7, v7
v_rcp_f32 v14, v14
v_rcp_f32 v15, v15
v_mfma_f32_32x32x16_bf16 v[96:111], v[200:203], v[88:91], v[96:111]
ds_read_b128 v[80:83], v30 offset:20480
ds_read_b128 v[84:87], v30 offset:21504
v_mul_f32 v136, v136, v6
v_mul_f32 v137, v137, v7
v_mul_f32 v138, v138, v14
v_mul_f32 v139, v139, v15
v_cvt_pk_bf16_f32 v58, v136, v137
s_waitcnt vmcnt(4)
s_barrier
buffer_store_byte v25, v24, s[48:51], s13 offen
v_mfma_f32_32x32x16_bf16 v[96:111], v[204:207], v[92:95], v[96:111]
v_cvt_pk_bf16_f32 v59, v138, v139
v_mul_f32 v136, v120, v18
v_mul_f32 v137, v121, v18
v_mul_f32 v138, v122, v18
v_mul_f32 v139, v123, v18
v_fma_f32 v6, -v136, v136, -s84
s_waitcnt lgkmcnt(3)
v_mfma_f32_32x32x16_bf16 v[96:111], v[208:211], v[64:67], v[96:111]
ds_read_b128 v[88:91], v30 offset:22528
ds_read_b128 v[92:95], v30 offset:23552
buffer_load_dwordx4 v11, s[36:39], s72 offen offset:3072 lds
buffer_store_dwordx4 v[56:59], v5, s[48:51], s19 offen sc1
v_fma_f32 v7, -v137, v137, -s84
v_fma_f32 v14, -v138, v138, -s84
v_fma_f32 v15, -v139, v139, -s84
v_mul_f32 v6, v136, v6
v_mul_f32 v7, v137, v7
v_mfma_f32_32x32x16_bf16 v[96:111], v[212:215], v[68:71], v[96:111]
v_mul_f32 v14, v138, v14
v_mul_f32 v15, v139, v15
v_exp_f32 v6, v6
v_exp_f32 v7, v7
v_mfma_f32_32x32x16_bf16 v[96:111], v[216:219], v[72:75], v[96:111]
ds_read_b128 v[64:67], v30 offset:24576
ds_read_b128 v[68:71], v30 offset:25600
v_exp_f32 v14, v14
v_exp_f32 v15, v15
v_fma_f32 v6, v6, s82, s82
s_add_u32 m0, s60, 49152
v_mfma_f32_32x32x16_bf16 v[96:111], v[220:223], v[76:79], v[96:111]
buffer_load_dwordx4 v8, s[36:39], s73 offen lds
v_fma_f32 v7, v7, s82, s82
v_fma_f32 v14, v14, s82, s82
v_fma_f32 v15, v15, s82, s82
v_rcp_f32 v6, v6
s_waitcnt lgkmcnt(2)
v_mfma_f32_32x32x16_bf16 v[96:111], v[224:227], v[80:83], v[96:111]
ds_read_b128 v[72:75], v30 offset:26624
ds_read_b128 v[76:79], v30 offset:27648
v_rcp_f32 v7, v7
v_rcp_f32 v14, v14
v_rcp_f32 v15, v15
v_mfma_f32_32x32x16_bf16 v[96:111], v[228:231], v[84:87], v[96:111]
v_mul_f32 v136, v136, v6
v_mul_f32 v137, v137, v7
v_mul_f32 v138, v138, v14
v_mul_f32 v139, v139, v15
v_cvt_pk_bf16_f32 v60, v136, v137
v_cvt_pk_bf16_f32 v61, v138, v139
v_mfma_f32_32x32x16_bf16 v[96:111], v[232:235], v[88:91], v[96:111]
ds_read_b128 v[80:83], v30 offset:28672
ds_read_b128 v[84:87], v30 offset:29696
buffer_load_dwordx4 v9, s[36:39], s73 offen offset:1024 lds
v_mul_f32 v136, v124, v18
v_mul_f32 v137, v125, v18
v_mul_f32 v138, v126, v18
v_mul_f32 v139, v127, v18
v_fma_f32 v6, -v136, v136, -s84
v_mfma_f32_32x32x16_bf16 v[96:111], v[236:239], v[92:95], v[96:111]
v_fma_f32 v7, -v137, v137, -s84
v_fma_f32 v14, -v138, v138, -s84
v_fma_f32 v15, -v139, v139, -s84
v_mul_f32 v6, v136, v6
v_mul_f32 v7, v137, v7
v_mul_f32 v14, v138, v14
s_waitcnt lgkmcnt(2)
v_mfma_f32_32x32x16_bf16 v[96:111], v[240:243], v[64:67], v[96:111]
ds_read_b128 v[88:91], v30 offset:30720
ds_read_b128 v[92:95], v30 offset:31744
v_mul_f32 v15, v139, v15
v_exp_f32 v6, v6
v_exp_f32 v7, v7
s_add_u32 m0, s60, 120832
v_mfma_f32_32x32x16_bf16 v[96:111], v[244:247], v[68:71], v[96:111]
buffer_load_dwordx4 v10, s[36:39], s73 offen offset:2048 lds
v_exp_f32 v14, v14
v_exp_f32 v15, v15
v_fma_f32 v6, v6, s82, s82
v_fma_f32 v7, v7, s82, s82
v_mfma_f32_32x32x16_bf16 v[96:111], v[248:251], v[72:75], v[96:111]
ds_read_b128 v[64:67], v30 offset:32768
ds_read_b128 v[68:71], v30 offset:33792
v_fma_f32 v14, v14, s82, s82
v_fma_f32 v15, v15, s82, s82
v_rcp_f32 v6, v6
v_rcp_f32 v7, v7
v_mfma_f32_32x32x16_bf16 v[96:111], v[252:255], v[76:79], v[96:111]
buffer_load_dwordx4 v11, s[36:39], s73 offen offset:3072 lds
v_rcp_f32 v14, v14
v_rcp_f32 v15, v15
v_mul_f32 v136, v136, v6
s_waitcnt lgkmcnt(2)
v_mfma_f32_32x32x16_bf16 v[112:127], v[144:147], v[80:83], 0
ds_read_b128 v[72:75], v30 offset:34816
ds_read_b128 v[76:79], v30 offset:35840
v_mul_f32 v137, v137, v7
v_mul_f32 v138, v138, v14
v_mul_f32 v139, v139, v15
v_cvt_pk_bf16_f32 v62, v136, v137
v_cvt_pk_bf16_f32 v63, v138, v139
v_mfma_f32_32x32x16_bf16 v[112:127], v[148:151], v[84:87], v[112:127]
buffer_store_dwordx4 v[60:63], v5, s[48:51], s19 offen offset:1024 sc1
v_mfma_f32_32x32x16_bf16 v[112:127], v[152:155], v[88:91], v[112:127]
ds_read_b128 v[80:83], v30 offset:36864
s_add_u32 m0, s60, 131072
ds_read_b128 v[84:87], v30 offset:37888
buffer_load_dwordx4 v8, s[36:39], s74 offen lds
s_buffer_load_dwordx2 s[0:1], s[48:51], s13 offset:0
v_mul_f32 v136, v96, v20
v_mul_f32 v137, v97, v20
v_mul_f32 v138, v98, v20
v_mul_f32 v139, v99, v20
v_fma_f32 v6, -v136, v136, -s84
v_fma_f32 v7, -v137, v137, -s84
v_mfma_f32_32x32x16_bf16 v[112:127], v[156:159], v[92:95], v[112:127]
v_fma_f32 v14, -v138, v138, -s84
v_fma_f32 v15, -v139, v139, -s84
v_mul_f32 v6, v136, v6
v_mul_f32 v7, v137, v7
v_mul_f32 v14, v138, v14
v_mul_f32 v15, v139, v15
s_waitcnt lgkmcnt(2)
v_mfma_f32_32x32x16_bf16 v[112:127], v[160:163], v[64:67], v[112:127]
ds_read_b128 v[88:91], v30 offset:38912
ds_read_b128 v[92:95], v30 offset:39936
v_exp_f32 v6, v6
v_exp_f32 v7, v7
v_exp_f32 v14, v14
v_mfma_f32_32x32x16_bf16 v[112:127], v[164:167], v[68:71], v[112:127]
buffer_load_dwordx4 v9, s[36:39], s74 offen offset:1024 lds
v_exp_f32 v15, v15
v_fma_f32 v6, v6, s82, s82
v_fma_f32 v7, v7, s82, s82
v_fma_f32 v14, v14, s82, s82
v_fma_f32 v15, v15, s82, s82
v_mfma_f32_32x32x16_bf16 v[112:127], v[168:171], v[72:75], v[112:127]
ds_read_b128 v[64:67], v30 offset:40960
ds_read_b128 v[68:71], v30 offset:41984
v_rcp_f32 v6, v6
v_rcp_f32 v7, v7
v_rcp_f32 v14, v14
v_mfma_f32_32x32x16_bf16 v[112:127], v[172:175], v[76:79], v[112:127]
ds_read_b128 a[228:231], v40 offset:28672
v_rcp_f32 v15, v15
v_mul_f32 v136, v136, v6
v_mul_f32 v137, v137, v7
v_mul_f32 v138, v138, v14
v_mul_f32 v139, v139, v15
v_cvt_pk_bf16_f32 v144, v136, v137
s_waitcnt lgkmcnt(3)
v_mfma_f32_32x32x16_bf16 v[112:127], v[176:179], v[80:83], v[112:127]
ds_read_b128 v[72:75], v30 offset:43008
s_add_u32 m0, s60, 137216
ds_read_b128 v[76:79], v30 offset:44032
buffer_load_dwordx4 v10, s[36:39], s74 offen offset:2048 lds
v_cvt_pk_bf16_f32 v145, v138, v139
v_mul_f32 v136, v100, v20
v_mul_f32 v137, v101, v20
v_mul_f32 v138, v102, v20
v_mul_f32 v139, v103, v20
v_fma_f32 v6, -v136, v136, -s84
v_mfma_f32_32x32x16_bf16 v[112:127], v[180:183], v[84:87], v[112:127]
v_fma_f32 v7, -v137, v137, -s84
v_fma_f32 v14, -v138, v138, -s84
v_fma_f32 v15, -v139, v139, -s84
v_mul_f32 v6, v136, v6
v_mul_f32 v7, v137, v7
v_mul_f32 v14, v138, v14
v_mfma_f32_32x32x16_bf16 v[112:127], v[184:187], v[88:91], v[112:127]
ds_read_b128 v[80:83], v30 offset:45056
ds_read_b128 v[84:87], v30 offset:46080
v_mul_f32 v15, v139, v15
v_exp_f32 v6, v6
v_exp_f32 v7, v7
v_exp_f32 v14, v14
s_waitcnt lgkmcnt(0)
s_cmp_lg_u64 s[0:1], s[16:17]
s_cbranch_scc1 L_spin2
L_back2:
v_mfma_f32_32x32x16_bf16 v[112:127], v[188:191], v[92:95], v[112:127]
buffer_load_dwordx4 v11, s[36:39], s74 offen offset:3072 lds
buffer_load_dwordx4 v[152:155], v31, s[48:51], s5 offen sc1
v_exp_f32 v15, v15
v_fma_f32 v6, v6, s82, s82
v_fma_f32 v7, v7, s82, s82
v_fma_f32 v14, v14, s82, s82
v_mfma_f32_32x32x16_bf16 v[112:127], v[192:195], v[64:67], v[112:127]
ds_read_b128 v[88:91], v30 offset:47104
ds_read_b128 v[92:95], v30 offset:48128
v_fma_f32 v15, v15, s82, s82
v_rcp_f32 v6, v6
v_rcp_f32 v7, v7
v_rcp_f32 v14, v14
v_mfma_f32_32x32x16_bf16 v[112:127], v[196:199], v[68:71], v[112:127]
buffer_load_dwordx4 v[156:159], v31, s[48:51], s5 offen offset:1024 sc1
v_rcp_f32 v15, v15
v_mul_f32 v136, v136, v6
v_mul_f32 v137, v137, v7
v_mul_f32 v138, v138, v14
v_mul_f32 v139, v139, v15
v_mfma_f32_32x32x16_bf16 v[112:127], v[200:203], v[72:75], v[112:127]
ds_read_b128 v[64:67], v30 offset:49152
ds_read_b128 v[68:71], v30 offset:50176
v_cvt_pk_bf16_f32 v146, v136, v137
v_cvt_pk_bf16_f32 v147, v138, v139
v_mul_f32 v136, v104, v20
v_mul_f32 v137, v105, v20
v_mul_f32 v138, v106, v20
v_mul_f32 v139, v107, v20
v_mfma_f32_32x32x16_bf16 v[112:127], v[204:207], v[76:79], v[112:127]
buffer_store_dwordx4 v[144:147], v29, s[48:51], s18 offen sc1
buffer_load_dwordx4 v[160:163], v31, s[48:51], s6 offen sc1
v_fma_f32 v6, -v136, v136, -s84
v_fma_f32 v7, -v137, v137, -s84
v_fma_f32 v14, -v138, v138, -s84
v_fma_f32 v15, -v139, v139, -s84
v_mul_f32 v6, v136, v6
v_mul_f32 v7, v137, v7
s_waitcnt lgkmcnt(2)
v_mfma_f32_32x32x16_bf16 v[112:127], v[208:211], v[80:83], v[112:127]
ds_read_b128 v[72:75], v30 offset:51200
ds_read_b128 v[76:79], v30 offset:52224
ds_read_b64_tr_b16 a[40:41], v12 offset:8192
ds_read_b64_tr_b16 a[42:43], v12 offset:9216
v_mul_f32 v14, v138, v14
v_mul_f32 v15, v139, v15
v_exp_f32 v6, v6
v_exp_f32 v7, v7
v_mfma_f32_32x32x16_bf16 v[112:127], v[212:215], v[84:87], v[112:127]
ds_read_b64_tr_b16 a[44:45], v12 offset:8704
ds_read_b64_tr_b16 a[46:47], v12 offset:9728
buffer_load_dwordx4 v[164:167], v31, s[48:51], s6 offen offset:1024 sc1
v_exp_f32 v14, v14
v_exp_f32 v15, v15
v_fma_f32 v6, v6, s82, s82
v_fma_f32 v7, v7, s82, s82
v_mov_b32 v132, v23
v_mfma_f32_32x32x16_bf16 v[112:127], v[216:219], v[88:91], v[112:127]
ds_read_b128 v[80:83], v30 offset:53248
ds_read_b128 v[84:87], v30 offset:54272
ds_read_b64_tr_b16 a[0:1], v12 offset:0
ds_read_b64_tr_b16 a[2:3], v12 offset:1024
v_fma_f32 v14, v14, s82, s82
v_mfma_f32_32x32x16_bf16 v[112:127], v[128:131], v[132:135], v[112:127]
v_fma_f32 v15, v15, s82, s82
v_rcp_f32 v6, v6
v_rcp_f32 v7, v7
v_rcp_f32 v14, v14
v_rcp_f32 v15, v15
v_mul_f32 v136, v136, v6
v_mfma_f32_32x32x16_bf16 v[112:127], v[220:223], v[92:95], v[112:127]
ds_read_b64_tr_b16 a[4:5], v12 offset:512
ds_read_b64_tr_b16 a[6:7], v12 offset:1536
buffer_load_dwordx4 v[168:171], v31, s[48:51], s7 offen sc1
v_mul_f32 v137, v137, v7
v_mul_f32 v138, v138, v14
v_mul_f32 v139, v139, v15
v_cvt_pk_bf16_f32 v148, v136, v137
v_cvt_pk_bf16_f32 v149, v138, v139
v_mul_f32 v136, v108, v20
s_waitcnt lgkmcnt(10)
v_mfma_f32_32x32x16_bf16 v[112:127], v[224:227], v[64:67], v[112:127]
ds_read_b128 v[88:91], v30 offset:55296
ds_read_b128 v[92:95], v30 offset:56320
ds_read_b64_tr_b16 a[8:9], v12 offset:16384
ds_read_b64_tr_b16 a[10:11], v12 offset:17408
v_mul_f32 v137, v109, v20
v_mul_f32 v138, v110, v20
v_mul_f32 v139, v111, v20
v_fma_f32 v6, -v136, v136, -s84
v_fma_f32 v7, -v137, v137, -s84
v_fma_f32 v14, -v138, v138, -s84
s_waitcnt vmcnt(10)
s_barrier
buffer_store_byte v25, v24, s[48:51], s13 offen offset:1024
v_mfma_f32_32x32x16_bf16 v[112:127], v[228:231], v[68:71], v[112:127]
ds_read_b64_tr_b16 a[12:13], v12 offset:16896
ds_read_b64_tr_b16 a[14:15], v12 offset:17920
buffer_load_dwordx4 v[172:175], v31, s[48:51], s7 offen offset:1024 sc1
v_fma_f32 v15, -v139, v139, -s84
v_mul_f32 v6, v136, v6
v_mul_f32 v7, v137, v7
v_mul_f32 v14, v138, v14
v_mul_f32 v15, v139, v15
v_exp_f32 v6, v6
v_mfma_f32_32x32x16_bf16 v[112:127], v[232:235], v[72:75], v[112:127]
ds_read_b64_tr_b16 a[48:49], v12 offset:24576
ds_read_b64_tr_b16 a[50:51], v12 offset:25600
v_exp_f32 v7, v7
v_exp_f32 v14, v14
v_exp_f32 v15, v15
v_mfma_f32_32x32x16_bf16 v[112:127], v[236:239], v[76:79], v[112:127]
ds_read_b64_tr_b16 a[52:53], v12 offset:25088
ds_read_b64_tr_b16 a[54:55], v12 offset:26112
buffer_load_dwordx4 v[176:179], v31, s[48:51], s8 offen sc1
v_fma_f32 v6, v6, s82, s82
v_fma_f32 v7, v7, s82, s82
v_fma_f32 v14, v14, s82, s82
v_fma_f32 v15, v15, s82, s82
v_rcp_f32 v6, v6
s_waitcnt lgkmcnt(8)
v_mfma_f32_32x32x16_bf16 v[112:127], v[240:243], v[80:83], v[112:127]
ds_read_b64_tr_b16 a[56:57], v12 offset:32768
ds_read_b64_tr_b16 a[58:59], v12 offset:33792
v_rcp_f32 v7, v7
v_rcp_f32 v14, v14
v_rcp_f32 v15, v15
v_mfma_f32_32x32x16_bf16 v[112:127], v[244:247], v[84:87], v[112:127]
ds_read_b64_tr_b16 a[60:61], v12 offset:33280
ds_read_b64_tr_b16 a[62:63], v12 offset:34304
buffer_load_dwordx4 v[180:183], v31, s[48:51], s8 offen offset:1024 sc1
v_mul_f32 v136, v136, v6
v_mul_f32 v137, v137, v7
v_mul_f32 v138, v138, v14
v_mul_f32 v139, v139, v15
v_cvt_pk_bf16_f32 v150, v136, v137
v_cvt_pk_bf16_f32 v151, v138, v139
v_mfma_f32_32x32x16_bf16 v[112:127], v[248:251], v[88:91], v[112:127]
buffer_store_dwordx4 v[148:151], v29, s[48:51], s18 offen offset:1024 sc1
ds_read_b64_tr_b16 a[64:65], v12 offset:40960
ds_read_b64_tr_b16 a[66:67], v12 offset:41984
v_mfma_f32_32x32x16_bf16 v[112:127], v[252:255], v[92:95], v[112:127]
ds_read_b64_tr_b16 a[68:69], v12 offset:41472
ds_read_b64_tr_b16 a[70:71], v12 offset:42496
buffer_load_dwordx4 v[184:187], v31, s[48:51], s9 offen sc1
s_nop 8
v_pk_mul_f32 v[112:113], v[112:113], v[22:23] op_sel_hi:[1,0]
v_pk_mul_f32 v[114:115], v[114:115], v[22:23] op_sel_hi:[1,0]
v_pk_mul_f32 v[116:117], v[116:117], v[22:23] op_sel_hi:[1,0]
v_pk_mul_f32 v[118:119], v[118:119], v[22:23] op_sel_hi:[1,0]
v_pk_fma_f32 v[64:65], v[112:113], v[112:113], s[84:85] neg_lo:[1,0,1] neg_hi:[1,0,1]
v_pk_fma_f32 v[66:67], v[114:115], v[114:115], s[84:85] neg_lo:[1,0,1] neg_hi:[1,0,1]
v_pk_fma_f32 v[68:69], v[116:117], v[116:117], s[84:85] neg_lo:[1,0,1] neg_hi:[1,0,1]
v_pk_fma_f32 v[70:71], v[118:119], v[118:119], s[84:85] neg_lo:[1,0,1] neg_hi:[1,0,1]
v_pk_mul_f32 v[64:65], v[112:113], v[64:65]
v_pk_mul_f32 v[66:67], v[114:115], v[66:67]
v_pk_mul_f32 v[68:69], v[116:117], v[68:69]
v_pk_mul_f32 v[70:71], v[118:119], v[70:71]
v_exp_f32 v64, v64
v_exp_f32 v65, v65
v_exp_f32 v66, v66
v_exp_f32 v67, v67
buffer_load_dwordx4 v[188:191], v31, s[48:51], s9 offen offset:1024 sc1
v_exp_f32 v68, v68
v_exp_f32 v69, v69
v_exp_f32 v70, v70
v_exp_f32 v71, v71
v_pk_fma_f32 v[64:65], v[64:65], s[82:83], s[82:83]
v_pk_fma_f32 v[66:67], v[66:67], s[82:83], s[82:83]
v_pk_fma_f32 v[68:69], v[68:69], s[82:83], s[82:83]
v_pk_fma_f32 v[70:71], v[70:71], s[82:83], s[82:83]
v_rcp_f32 v64, v64
v_rcp_f32 v65, v65
v_rcp_f32 v66, v66
v_rcp_f32 v67, v67
v_rcp_f32 v68, v68
v_rcp_f32 v69, v69
v_rcp_f32 v70, v70
v_rcp_f32 v71, v71
v_pk_mul_f32 v[112:113], v[112:113], v[64:65]
v_pk_mul_f32 v[114:115], v[114:115], v[66:67]
v_pk_mul_f32 v[116:117], v[116:117], v[68:69]
v_pk_mul_f32 v[118:119], v[118:119], v[70:71]
buffer_load_dwordx4 v[192:195], v31, s[48:51], s10 offen sc1
v_cvt_pk_bf16_f32 v200, v112, v113
v_cvt_pk_bf16_f32 v201, v114, v115
v_cvt_pk_bf16_f32 v202, v116, v117
v_cvt_pk_bf16_f32 v203, v118, v119
buffer_store_dwordx4 v[200:203], v29, s[48:51], s19 offen sc1
v_pk_mul_f32 v[120:121], v[120:121], v[22:23] op_sel_hi:[1,0]
v_pk_mul_f32 v[122:123], v[122:123], v[22:23] op_sel_hi:[1,0]
v_pk_mul_f32 v[124:125], v[124:125], v[22:23] op_sel_hi:[1,0]
v_pk_mul_f32 v[126:127], v[126:127], v[22:23] op_sel_hi:[1,0]
v_pk_fma_f32 v[64:65], v[120:121], v[120:121], s[84:85] neg_lo:[1,0,1] neg_hi:[1,0,1]
v_pk_fma_f32 v[66:67], v[122:123], v[122:123], s[84:85] neg_lo:[1,0,1] neg_hi:[1,0,1]
v_pk_fma_f32 v[68:69], v[124:125], v[124:125], s[84:85] neg_lo:[1,0,1] neg_hi:[1,0,1]
v_pk_fma_f32 v[70:71], v[126:127], v[126:127], s[84:85] neg_lo:[1,0,1] neg_hi:[1,0,1]
v_pk_mul_f32 v[64:65], v[120:121], v[64:65]
v_pk_mul_f32 v[66:67], v[122:123], v[66:67]
v_pk_mul_f32 v[68:69], v[124:125], v[68:69]
v_pk_mul_f32 v[70:71], v[126:127], v[70:71]
v_exp_f32 v64, v64
v_exp_f32 v65, v65
v_exp_f32 v66, v66
v_exp_f32 v67, v67
buffer_load_dwordx4 v[196:199], v31, s[48:51], s10 offen offset:1024 sc1
v_add_u32 v31, 114688, v31
v_exp_f32 v68, v68
s_waitcnt lgkmcnt(0)
s_buffer_load_dwordx2 s[0:1], s[48:51], s13 offset:1024
v_exp_f32 v69, v69
v_exp_f32 v70, v70
v_exp_f32 v71, v71
v_pk_fma_f32 v[64:65], v[64:65], s[82:83], s[82:83]
v_pk_fma_f32 v[66:67], v[66:67], s[82:83], s[82:83]
v_pk_fma_f32 v[68:69], v[68:69], s[82:83], s[82:83]
v_pk_fma_f32 v[70:71], v[70:71], s[82:83], s[82:83]
v_rcp_f32 v64, v64
v_rcp_f32 v65, v65
v_rcp_f32 v66, v66
v_rcp_f32 v67, v67
v_rcp_f32 v68, v68
v_rcp_f32 v69, v69
v_rcp_f32 v70, v70
v_rcp_f32 v71, v71
v_pk_mul_f32 v[120:121], v[120:121], v[64:65]
v_pk_mul_f32 v[122:123], v[122:123], v[66:67]
v_pk_mul_f32 v[124:125], v[124:125], v[68:69]
v_pk_mul_f32 v[126:127], v[126:127], v[70:71]
v_cvt_pk_bf16_f32 v204, v120, v121
v_cvt_pk_bf16_f32 v205, v122, v123
v_cvt_pk_bf16_f32 v206, v124, v125
v_cvt_pk_bf16_f32 v207, v126, v127
buffer_store_dwordx4 v[204:207], v29, s[48:51], s19 offen offset:1024 sc1
v_mfma_f32_32x32x16_bf16 v[64:79], a[0:3], v[48:51], 0
ds_read_b64_tr_b16 a[72:73], v13 offset:0
ds_read_b64_tr_b16 a[74:75], v13 offset:1024
v_mfma_f32_32x32x16_bf16 v[80:95], a[4:7], v[48:51], 0
ds_read_b64_tr_b16 a[76:77], v13 offset:512
ds_read_b64_tr_b16 a[78:79], v13 offset:1536
v_mfma_f32_32x32x16_bf16 v[64:79], a[8:11], v[52:55], v[64:79]
ds_read_b64_tr_b16 a[80:81], v12 offset:49152
ds_read_b64_tr_b16 a[82:83], v12 offset:50176
s_mul_i32 s58, s52, 6144
s_add_u32 s58, s58, 57344
s_waitcnt vmcnt(6)
s_barrier
buffer_store_byte v25, v24, s[48:51], s13 offen offset:2048
v_mfma_f32_32x32x16_bf16 v[80:95], a[12:15], v[52:55], v[80:95]
ds_read_b64_tr_b16 a[84:85], v12 offset:49664
ds_read_b64_tr_b16 a[86:87], v12 offset:50688
v_add_u32 v140, s58, v5
s_xor_b32 s58, s52, 1
v_mfma_f32_32x32x16_bf16 v[64:79], a[16:19], v[152:155], v[64:79]
ds_read_b64_tr_b16 a[88:89], v13 offset:8192
ds_read_b64_tr_b16 a[90:91], v13 offset:9216
s_mul_i32 s58, s58, 6144
v_mfma_f32_32x32x16_bf16 v[80:95], a[20:23], v[152:155], v[80:95]
ds_read_b64_tr_b16 a[92:93], v13 offset:8704
ds_read_b64_tr_b16 a[94:95], v13 offset:9728
s_add_u32 s58, s58, 57344
v_add_u32 v141, s58, v5
s_waitcnt lgkmcnt(0)
s_cmp_lg_u64 s[0:1], s[16:17]
s_cbranch_scc1 L_spin3
L_back3:
v_mfma_f32_32x32x16_bf16 v[64:79], a[24:27], v[156:159], v[64:79]
ds_read_b64_tr_b16 a[96:97], v13 offset:16384
ds_read_b64_tr_b16 a[98:99], v13 offset:17408
buffer_load_dwordx4 v[208:211], v31, s[48:51], s5 offen sc1
s_xor_b32 s58, s52, 2
s_mul_i32 s58, s58, 6144
v_mfma_f32_32x32x16_bf16 v[80:95], a[28:31], v[156:159], v[80:95]
ds_read_b64_tr_b16 a[100:101], v13 offset:16896
ds_read_b64_tr_b16 a[102:103], v13 offset:17920
s_add_u32 s58, s58, 57344
v_add_u32 v142, s58, v5
v_mfma_f32_32x32x16_bf16 v[64:79], a[32:35], v[160:163], v[64:79]
ds_read_b64_tr_b16 a[104:105], v13 offset:24576
ds_read_b64_tr_b16 a[106:107], v13 offset:25600
buffer_load_dwordx4 v[212:215], v31, s[48:51], s5 offen offset:1024 sc1
s_xor_b32 s58, s52, 3
s_mul_i32 s58, s58, 6144
v_mfma_f32_32x32x16_bf16 v[80:95], a[36:39], v[160:163], v[80:95]
ds_read_b64_tr_b16 a[108:109], v13 offset:25088
ds_read_b64_tr_b16 a[110:111], v13 offset:26112
s_add_u32 s58, s58, 57344
v_mfma_f32_32x32x16_bf16 v[80:95], a[44:47], v[164:167], v[80:95]
buffer_load_dwordx4 v[216:219], v31, s[48:51], s6 offen sc1
v_add_u32 v143, s58, v5
v_lshrrev_b32 v7, 1, v1
v_mfma_f32_32x32x16_bf16 v[80:95], a[52:55], v[168:171], v[80:95]
v_lshlrev_b32 v7, 26, v7
v_lshl_add_u32 v6, v1, 8, v7
v_mfma_f32_32x32x16_bf16 v[80:95], a[60:63], v[172:175], v[80:95]
buffer_load_dwordx4 v[220:223], v31, s[48:51], s6 offen offset:1024 sc1
s_waitcnt lgkmcnt(0)
s_buffer_load_dwordx2 s[0:1], s[48:51], s13 offset:2048
v_mfma_f32_32x32x16_bf16 v[80:95], a[68:71], v[176:179], v[80:95]
v_mfma_f32_32x32x16_bf16 v[80:95], a[76:79], v[180:183], v[80:95]
buffer_load_dwordx4 v[224:227], v31, s[48:51], s7 offen sc1
s_waitcnt vmcnt(11)
v_mfma_f32_32x32x16_bf16 v[80:95], a[84:87], v[184:187], v[80:95]
s_waitcnt vmcnt(10)
v_mfma_f32_32x32x16_bf16 v[80:95], a[92:95], v[188:191], v[80:95]
buffer_load_dwordx4 v[228:231], v31, s[48:51], s7 offen offset:1024 sc1
s_waitcnt vmcnt(10)
v_mfma_f32_32x32x16_bf16 v[80:95], a[100:103], v[192:195], v[80:95]
s_waitcnt vmcnt(8)
v_mfma_f32_32x32x16_bf16 v[80:95], a[108:111], v[196:199], v[80:95]
buffer_load_dwordx4 v[232:235], v31, s[48:51], s8 offen sc1
v_mfma_f32_32x32x16_bf16 v[64:79], a[40:43], v[164:167], v[64:79]
v_mfma_f32_32x32x16_bf16 v[64:79], a[48:51], v[168:171], v[64:79]
buffer_load_dwordx4 v[236:239], v31, s[48:51], s8 offen offset:1024 sc1
s_waitcnt vmcnt(9)
s_barrier
buffer_store_byte v25, v24, s[48:51], s13 offen offset:3072
v_mfma_f32_32x32x16_bf16 v[64:79], a[56:59], v[172:175], v[64:79]
v_mfma_f32_32x32x16_bf16 v[64:79], a[64:67], v[176:179], v[64:79]
buffer_load_dwordx4 v[240:243], v31, s[48:51], s9 offen sc1
s_waitcnt lgkmcnt(0)
s_cmp_lg_u64 s[0:1], s[16:17]
s_cbranch_scc1 L_spin4
L_back4:
v_mfma_f32_32x32x16_bf16 v[64:79], a[72:75], v[180:183], v[64:79]
ds_write_b128 v140, v[88:91] offset:32768
v_mfma_f32_32x32x16_bf16 v[64:79], a[80:83], v[184:187], v[64:79]
buffer_load_dwordx4 v[244:247], v31, s[48:51], s9 offen offset:1024 sc1
v_mfma_f32_32x32x16_bf16 v[64:79], a[88:91], v[188:191], v[64:79]
ds_write_b128 v140, v[92:95] offset:33792
v_mfma_f32_32x32x16_bf16 v[64:79], a[96:99], v[192:195], v[64:79]
buffer_load_dwordx4 v[248:251], v31, s[48:51], s10 offen sc1
v_mfma_f32_32x32x16_bf16 v[64:79], a[104:107], v[196:199], v[64:79]
ds_write_b128 v140, v[80:83] offset:30720
v_mfma_f32_32x32x16_bf16 v[96:111], a[0:3], v[56:59], 0
buffer_load_dwordx4 v[252:255], v31, s[48:51], s10 offen offset:1024 sc1
v_add_u32 v31, 114688, v31
v_mfma_f32_32x32x16_bf16 v[112:127], a[4:7], v[56:59], 0
ds_write_b128 v140, v[84:87] offset:31744
v_mfma_f32_32x32x16_bf16 v[96:111], a[8:11], v[60:63], v[96:111]
buffer_load_dwordx4 v[152:155], v31, s[48:51], s5 offen sc1
v_mfma_f32_32x32x16_bf16 v[112:127], a[12:15], v[60:63], v[112:127]
s_waitcnt vmcnt(13)
v_mfma_f32_32x32x16_bf16 v[96:111], a[16:19], v[208:211], v[96:111]
buffer_load_dwordx4 v[156:159], v31, s[48:51], s5 offen offset:1024 sc1
ds_write_b128 v140, v[72:75] offset:28672
v_mfma_f32_32x32x16_bf16 v[112:127], a[20:23], v[208:211], v[112:127]
ds_write_b128 v140, v[76:79] offset:29696
s_waitcnt vmcnt(13)
v_mfma_f32_32x32x16_bf16 v[96:111], a[24:27], v[212:215], v[96:111]
buffer_load_dwordx4 v[160:163], v31, s[48:51], s6 offen sc1
v_mfma_f32_32x32x16_bf16 v[112:127], a[28:31], v[212:215], v[112:127]
s_waitcnt lgkmcnt(0)
s_barrier
s_waitcnt vmcnt(13)
v_mfma_f32_32x32x16_bf16 v[96:111], a[32:35], v[216:219], v[96:111]
buffer_load_dwordx4 v[164:167], v31, s[48:51], s6 offen offset:1024 sc1
ds_read_b128 v[88:91], v143 offset:32768
ds_read_b128 v[92:95], v143 offset:33792
v_mfma_f32_32x32x16_bf16 v[112:127], a[36:39], v[216:219], v[112:127]
ds_read_b128 v[80:83], v142 offset:30720
ds_read_b128 v[84:87], v142 offset:31744
s_waitcnt vmcnt(13)
v_mfma_f32_32x32x16_bf16 v[96:111], a[40:43], v[220:223], v[96:111]
buffer_load_dwordx4 v[168:171], v31, s[48:51], s7 offen sc1
ds_read_b128 v[72:75], v141 offset:28672
ds_read_b128 v[76:79], v141 offset:29696
v_mfma_f32_32x32x16_bf16 v[112:127], a[44:47], v[220:223], v[112:127]
s_waitcnt vmcnt(13)
v_mfma_f32_32x32x16_bf16 v[96:111], a[48:51], v[224:227], v[96:111]
buffer_load_dwordx4 v[172:175], v31, s[48:51], s7 offen offset:1024 sc1
s_waitcnt lgkmcnt(5)
v_add_f32 v128, v64, v88
v_add_f32 v129, v65, v89
v_add_f32 v130, v66, v90
v_add_f32 v131, v67, v91
s_waitcnt lgkmcnt(4)
v_add_f32 v132, v68, v92
v_mfma_f32_32x32x16_bf16 v[112:127], a[52:55], v[224:227], v[112:127]
v_add_f32 v133, v69, v93
v_add_f32 v134, v70, v94
v_add_f32 v135, v71, v95
s_waitcnt lgkmcnt(3)
v_add_f32 v128, v128, v80
s_waitcnt vmcnt(13)
v_mfma_f32_32x32x16_bf16 v[96:111], a[56:59], v[228:231], v[96:111]
buffer_load_dwordx4 v[176:179], v31, s[48:51], s8 offen sc1
v_add_f32 v129, v129, v81
v_add_f32 v130, v130, v82
v_add_f32 v131, v131, v83
s_waitcnt lgkmcnt(2)
v_add_f32 v132, v132, v84
v_add_f32 v133, v133, v85
v_mfma_f32_32x32x16_bf16 v[112:127], a[60:63], v[228:231], v[112:127]
v_add_f32 v134, v134, v86
v_add_f32 v135, v135, v87
s_waitcnt lgkmcnt(1)
v_add_f32 v128, v128, v72
v_add_f32 v129, v129, v73
v_add_f32 v130, v130, v74
s_waitcnt vmcnt(13)
v_mfma_f32_32x32x16_bf16 v[112:127], a[68:71], v[232:235], v[112:127]
buffer_load_dwordx4 v[180:183], v31, s[48:51], s8 offen offset:1024 sc1
v_add_f32 v131, v131, v75
s_waitcnt lgkmcnt(0)
v_add_f32 v132, v132, v76
v_add_f32 v133, v133, v77
v_add_f32 v134, v134, v78
s_waitcnt vmcnt(13)
v_mfma_f32_32x32x16_bf16 v[112:127], a[76:79], v[236:239], v[112:127]
v_add_f32 v135, v135, v79
v_cvt_pk_bf16_f32 v136, v128, v129
v_cvt_pk_bf16_f32 v137, v130, v131
v_cvt_pk_bf16_f32 v138, v132, v133
v_cvt_pk_bf16_f32 v139, v134, v135
s_waitcnt vmcnt(11)
v_mfma_f32_32x32x16_bf16 v[112:127], a[84:87], v[240:243], v[112:127]
buffer_load_dwordx4 v[184:187], v31, s[48:51], s9 offen sc1
buffer_store_dwordx4 v[136:139], v5, s[48:51], s23 offen sc1
s_add_u32 s23, s23, 4096
s_waitcnt vmcnt(12)
v_mfma_f32_32x32x16_bf16 v[112:127], a[92:95], v[244:247], v[112:127]
s_waitcnt vmcnt(11)
v_mfma_f32_32x32x16_bf16 v[112:127], a[100:103], v[248:251], v[112:127]
buffer_load_dwordx4 v[188:191], v31, s[48:51], s9 offen offset:1024 sc1
s_buffer_load_dwordx2 s[0:1], s[48:51], s13 offset:3072
s_waitcnt vmcnt(11)
v_mfma_f32_32x32x16_bf16 v[112:127], a[108:111], v[252:255], v[112:127]
v_mfma_f32_32x32x16_bf16 v[96:111], a[64:67], v[232:235], v[96:111]
buffer_load_dwordx4 v[192:195], v31, s[48:51], s10 offen sc1
v_mfma_f32_32x32x16_bf16 v[96:111], a[72:75], v[236:239], v[96:111]
v_mfma_f32_32x32x16_bf16 v[96:111], a[80:83], v[240:243], v[96:111]
buffer_load_dwordx4 v[196:199], v31, s[48:51], s10 offen offset:1024 sc1
v_add_u32 v31, 114688, v31
v_mfma_f32_32x32x16_bf16 v[96:111], a[88:91], v[244:247], v[96:111]
v_mfma_f32_32x32x16_bf16 v[96:111], a[96:99], v[248:251], v[96:111]
s_nop 3
ds_write_b128 v140, v[120:123] offset:4096
v_mfma_f32_32x32x16_bf16 v[96:111], a[104:107], v[252:255], v[96:111]
ds_write_b128 v140, v[124:127] offset:5120
v_mfma_f32_32x32x16_bf16 v[64:79], a[0:3], v[144:147], 0
v_mfma_f32_32x32x16_bf16 v[80:95], a[4:7], v[144:147], 0
ds_write_b128 v140, v[112:115] offset:2048
s_waitcnt lgkmcnt(0)
s_cmp_lg_u64 s[0:1], s[16:17]
s_cbranch_scc1 L_spin5
L_back5:
v_mfma_f32_32x32x16_bf16 v[64:79], a[8:11], v[148:151], v[64:79]
buffer_load_dwordx4 v[208:211], v31, s[48:51], s5 offen sc1
v_mfma_f32_32x32x16_bf16 v[80:95], a[12:15], v[148:151], v[80:95]
ds_write_b128 v140, v[116:119] offset:3072
s_waitcnt vmcnt(13)
v_mfma_f32_32x32x16_bf16 v[64:79], a[16:19], v[152:155], v[64:79]
buffer_load_dwordx4 v[212:215], v31, s[48:51], s5 offen offset:1024 sc1
v_mfma_f32_32x32x16_bf16 v[80:95], a[20:23], v[152:155], v[80:95]
ds_write_b128 v140, v[104:107] offset:0
s_waitcnt vmcnt(13)
v_mfma_f32_32x32x16_bf16 v[64:79], a[24:27], v[156:159], v[64:79]
buffer_load_dwordx4 v[216:219], v31, s[48:51], s6 offen sc1
ds_write_b128 v140, v[108:111] offset:1024
s_waitcnt vmcnt(6)
buffer_store_byte v25, v6, s[48:51], s22 offen
v_mfma_f32_32x32x16_bf16 v[80:95], a[28:31], v[156:159], v[80:95]
s_waitcnt lgkmcnt(0)
s_barrier
v_mfma_f32_32x32x16_bf16 v[80:95], a[36:39], v[160:163], v[80:95]
buffer_load_dwordx4 v[220:223], v31, s[48:51], s6 offen offset:1024 sc1
ds_read_b128 v[120:123], v143 offset:4096
ds_read_b128 v[124:127], v143 offset:5120
v_mfma_f32_32x32x16_bf16 v[80:95], a[44:47], v[164:167], v[80:95]
ds_read_b128 v[112:115], v142 offset:2048
ds_read_b128 v[116:119], v142 offset:3072
v_mfma_f32_32x32x16_bf16 v[80:95], a[52:55], v[168:171], v[80:95]
buffer_load_dwordx4 v[224:227], v31, s[48:51], s7 offen sc1
ds_read_b128 v[104:107], v141 offset:0
ds_read_b128 v[108:111], v141 offset:1024
v_mfma_f32_32x32x16_bf16 v[80:95], a[60:63], v[172:175], v[80:95]
v_mfma_f32_32x32x16_bf16 v[80:95], a[68:71], v[176:179], v[80:95]
buffer_load_dwordx4 v[228:231], v31, s[48:51], s7 offen offset:1024 sc1
s_waitcnt lgkmcnt(5)
v_add_f32 v128, v96, v120
v_add_f32 v129, v97, v121
v_add_f32 v130, v98, v122
v_add_f32 v131, v99, v123
s_waitcnt lgkmcnt(4)
v_add_f32 v132, v100, v124
v_add_f32 v133, v101, v125
v_add_f32 v134, v102, v126
v_add_f32 v135, v103, v127
s_waitcnt lgkmcnt(3)
v_add_f32 v128, v128, v112
v_mfma_f32_32x32x16_bf16 v[80:95], a[76:79], v[180:183], v[80:95]
v_add_f32 v129, v129, v113
v_add_f32 v130, v130, v114
v_add_f32 v131, v131, v115
s_waitcnt lgkmcnt(2)
v_add_f32 v132, v132, v116
v_add_f32 v133, v133, v117
v_add_f32 v134, v134, v118
v_add_f32 v135, v135, v119
s_waitcnt lgkmcnt(1)
v_add_f32 v128, v128, v104
v_add_f32 v129, v129, v105
v_add_f32 v130, v130, v106
v_mfma_f32_32x32x16_bf16 v[80:95], a[84:87], v[184:187], v[80:95]
buffer_load_dwordx4 v[232:235], v31, s[48:51], s8 offen sc1
v_add_f32 v131, v131, v107
s_waitcnt lgkmcnt(0)
v_add_f32 v132, v132, v108
v_add_f32 v133, v133, v109
v_add_f32 v134, v134, v110
v_add_f32 v135, v135, v111
v_cvt_pk_bf16_f32 v136, v128, v129
v_cvt_pk_bf16_f32 v137, v130, v131
v_cvt_pk_bf16_f32 v138, v132, v133
v_cvt_pk_bf16_f32 v139, v134, v135
s_waitcnt vmcnt(10)
v_mfma_f32_32x32x16_bf16 v[80:95], a[92:95], v[188:191], v[80:95]
buffer_store_dwordx4 v[136:139], v5, s[48:51], s23 offen sc1
s_waitcnt vmcnt(10)
v_mfma_f32_32x32x16_bf16 v[80:95], a[100:103], v[192:195], v[80:95]
buffer_load_dwordx4 v[236:239], v31, s[48:51], s8 offen offset:1024 sc1
s_buffer_load_dword s0, s[48:51], s21 offset:0
s_waitcnt vmcnt(10)
v_mfma_f32_32x32x16_bf16 v[80:95], a[108:111], v[196:199], v[80:95]
v_mfma_f32_32x32x16_bf16 v[64:79], a[32:35], v[160:163], v[64:79]
buffer_load_dwordx4 v[240:243], v31, s[48:51], s9 offen sc1
v_mfma_f32_32x32x16_bf16 v[64:79], a[40:43], v[164:167], v[64:79]
v_mfma_f32_32x32x16_bf16 v[64:79], a[48:51], v[168:171], v[64:79]
buffer_load_dwordx4 v[244:247], v31, s[48:51], s9 offen offset:1024 sc1
v_mfma_f32_32x32x16_bf16 v[64:79], a[56:59], v[172:175], v[64:79]
v_mfma_f32_32x32x16_bf16 v[64:79], a[64:67], v[176:179], v[64:79]
buffer_load_dwordx4 v[248:251], v31, s[48:51], s10 offen sc1
s_nop 3
ds_write_b128 v140, v[88:91] offset:32768
v_mfma_f32_32x32x16_bf16 v[64:79], a[72:75], v[180:183], v[64:79]
v_mfma_f32_32x32x16_bf16 v[64:79], a[80:83], v[184:187], v[64:79]
buffer_load_dwordx4 v[252:255], v31, s[48:51], s10 offen offset:1024 sc1
ds_write_b128 v140, v[92:95] offset:33792
v_mfma_f32_32x32x16_bf16 v[64:79], a[88:91], v[188:191], v[64:79]
v_accvgpr_read_b32 v129, a224
v_lshlrev_b32 v128, 16, v129
v_mfma_f32_32x32x16_bf16 v[64:79], a[96:99], v[192:195], v[64:79]
ds_write_b128 v140, v[80:83] offset:30720
v_and_b32 v129, 0xffff0000, v129
v_accvgpr_read_b32 v131, a225
v_mfma_f32_32x32x16_bf16 v[64:79], a[104:107], v[196:199], v[64:79]
v_lshlrev_b32 v130, 16, v131
v_and_b32 v131, 0xffff0000, v131
v_mfma_f32_32x32x16_bf16 v[96:111], a[0:3], v[200:203], 0
ds_write_b128 v140, v[84:87] offset:31744
v_accvgpr_read_b32 v133, a226
v_lshlrev_b32 v132, 16, v133
s_waitcnt lgkmcnt(0)
s_cmp_lg_u32 s0, s14
s_cbranch_scc1 L_spin6
L_back6:
buffer_load_dwordx4 v[52:55], v5, s[48:51], s24 offen sc1
s_add_u32 s24, s24, 4096
v_mfma_f32_32x32x16_bf16 v[112:127], a[4:7], v[200:203], 0
v_and_b32 v133, 0xffff0000, v133
v_accvgpr_read_b32 v135, a227
v_mfma_f32_32x32x16_bf16 v[96:111], a[8:11], v[204:207], v[96:111]
v_lshlrev_b32 v134, 16, v135
v_and_b32 v135, 0xffff0000, v135
s_waitcnt vmcnt(6)
buffer_store_byte v25, v6, s[48:51], s22 offen offset:1024
v_mfma_f32_32x32x16_bf16 v[112:127], a[12:15], v[204:207], v[112:127]
ds_write_b128 v140, v[72:75] offset:28672
v_mfma_f32_32x32x16_bf16 v[96:111], a[16:19], v[208:211], v[96:111]
ds_write_b128 v140, v[76:79] offset:29696
v_add_f32 v128, v128, v64
v_add_f32 v129, v129, v65
v_add_f32 v130, v130, v66
v_add_f32 v131, v131, v67
v_mfma_f32_32x32x16_bf16 v[112:127], a[20:23], v[208:211], v[112:127]
v_add_f32 v132, v132, v68
v_add_f32 v133, v133, v69
v_add_f32 v134, v134, v70
v_add_f32 v135, v135, v71
s_waitcnt lgkmcnt(0)
s_barrier
v_mfma_f32_32x32x16_bf16 v[96:111], a[24:27], v[212:215], v[96:111]
ds_read_b128 v[88:91], v143 offset:32768
ds_read_b128 v[92:95], v143 offset:33792
v_mfma_f32_32x32x16_bf16 v[112:127], a[28:31], v[212:215], v[112:127]
ds_read_b128 v[80:83], v142 offset:30720
ds_read_b128 v[84:87], v142 offset:31744
v_mfma_f32_32x32x16_bf16 v[112:127], a[36:39], v[216:219], v[112:127]
ds_read_b128 v[72:75], v141 offset:28672
ds_read_b128 v[76:79], v141 offset:29696
v_mfma_f32_32x32x16_bf16 v[112:127], a[44:47], v[220:223], v[112:127]
s_waitcnt lgkmcnt(5)
v_add_f32 v128, v128, v88
v_add_f32 v129, v129, v89
v_add_f32 v130, v130, v90
v_add_f32 v131, v131, v91
v_mfma_f32_32x32x16_bf16 v[112:127], a[52:55], v[224:227], v[112:127]
s_waitcnt lgkmcnt(0)
s_buffer_load_dword s0, s[48:51], s21 offset:1024
v_add_f32 v132, v132, v92
v_add_f32 v133, v133, v93
v_add_f32 v134, v134, v94
v_add_f32 v135, v135, v95
v_mfma_f32_32x32x16_bf16 v[112:127], a[60:63], v[228:231], v[112:127]
v_add_f32 v128, v128, v80
v_add_f32 v129, v129, v81
v_add_f32 v130, v130, v82
v_add_f32 v131, v131, v83
v_add_f32 v132, v132, v84
v_mfma_f32_32x32x16_bf16 v[112:127], a[68:71], v[232:235], v[112:127]
v_add_f32 v133, v133, v85
v_add_f32 v134, v134, v86
v_add_f32 v135, v135, v87
v_add_f32 v128, v128, v72
s_waitcnt vmcnt(6)
v_mfma_f32_32x32x16_bf16 v[112:127], a[76:79], v[236:239], v[112:127]
v_add_f32 v129, v129, v73
v_add_f32 v130, v130, v74
v_add_f32 v131, v131, v75
v_add_f32 v132, v132, v76
s_waitcnt vmcnt(5)
v_mfma_f32_32x32x16_bf16 v[112:127], a[84:87], v[240:243], v[112:127]
v_add_f32 v133, v133, v77
v_add_f32 v134, v134, v78
v_add_f32 v135, v135, v79
s_waitcnt vmcnt(1)
v_lshlrev_b32 v48, 16, v52
v_mfma_f32_32x32x16_bf16 v[112:127], a[92:95], v[244:247], v[112:127]
v_and_b32 v49, 0xffff0000, v52
v_lshlrev_b32 v50, 16, v53
v_and_b32 v51, 0xffff0000, v53
v_lshlrev_b32 v52, 16, v54
v_mfma_f32_32x32x16_bf16 v[112:127], a[100:103], v[248:251], v[112:127]
v_and_b32 v53, 0xffff0000, v54
v_lshlrev_b32 v54, 16, v55
v_and_b32 v55, 0xffff0000, v55
v_add_f32 v128, v128, v48
v_mfma_f32_32x32x16_bf16 v[112:127], a[108:111], v[252:255], v[112:127]
v_add_f32 v129, v129, v49
v_add_f32 v130, v130, v50
v_add_f32 v131, v131, v51
v_add_f32 v132, v132, v52
v_add_f32 v133, v133, v53
v_mfma_f32_32x32x16_bf16 v[96:111], a[32:35], v[216:219], v[96:111]
v_add_f32 v134, v134, v54
v_add_f32 v135, v135, v55
v_cvt_pk_bf16_f32 v136, v128, v129
v_cvt_pk_bf16_f32 v138, v132, v133
v_mfma_f32_32x32x16_bf16 v[96:111], a[40:43], v[220:223], v[96:111]
v_cvt_pk_bf16_f32 v137, v130, v131
v_cvt_pk_bf16_f32 v139, v134, v135
v_permlane32_swap_b32 v136, v138
s_nop 0
v_permlane32_swap_b32 v137, v139
s_waitcnt lgkmcnt(0)
s_cmp_lg_u32 s0, s14
s_cbranch_scc1 L_spin7
L_back7:
buffer_load_dwordx4 v[60:63], v5, s[48:51], s24 offen sc1
v_mfma_f32_32x32x16_bf16 v[96:111], a[48:51], v[224:227], v[96:111]
buffer_store_dwordx4 v[136:139], v41, s[40:43], s44 offen
s_add_u32 s44, s44, 28672
v_accvgpr_read_b32 v129, a228
v_mfma_f32_32x32x16_bf16 v[96:111], a[56:59], v[228:231], v[96:111]
ds_write_b128 v140, v[120:123] offset:4096
v_lshlrev_b32 v128, 16, v129
v_and_b32 v129, 0xffff0000, v129
v_mfma_f32_32x32x16_bf16 v[96:111], a[64:67], v[232:235], v[96:111]
ds_write_b128 v140, v[124:127] offset:5120
v_accvgpr_read_b32 v131, a229
v_mfma_f32_32x32x16_bf16 v[96:111], a[72:75], v[236:239], v[96:111]
v_lshlrev_b32 v130, 16, v131
v_and_b32 v131, 0xffff0000, v131
v_mfma_f32_32x32x16_bf16 v[96:111], a[80:83], v[240:243], v[96:111]
ds_write_b128 v140, v[112:115] offset:2048
v_accvgpr_read_b32 v133, a230
v_mfma_f32_32x32x16_bf16 v[96:111], a[88:91], v[244:247], v[96:111]
v_lshlrev_b32 v132, 16, v133
v_and_b32 v133, 0xffff0000, v133
v_mfma_f32_32x32x16_bf16 v[96:111], a[96:99], v[248:251], v[96:111]
ds_write_b128 v140, v[116:119] offset:3072
v_accvgpr_read_b32 v135, a231
v_mfma_f32_32x32x16_bf16 v[96:111], a[104:107], v[252:255], v[96:111]
v_lshlrev_b32 v134, 16, v135
v_and_b32 v135, 0xffff0000, v135
s_nop 9
ds_write_b128 v140, v[104:107] offset:0
ds_write_b128 v140, v[108:111] offset:1024
v_pk_add_f32 v[128:129], v[128:129], v[96:97]
v_pk_add_f32 v[130:131], v[130:131], v[98:99]
v_pk_add_f32 v[132:133], v[132:133], v[100:101]
v_pk_add_f32 v[134:135], v[134:135], v[102:103]
s_waitcnt lgkmcnt(0)
s_barrier
ds_read_b128 v[120:123], v143 offset:4096
ds_read_b128 v[124:127], v143 offset:5120
ds_read_b128 v[112:115], v142 offset:2048
ds_read_b128 v[116:119], v142 offset:3072
ds_read_b128 v[104:107], v141 offset:0
ds_read_b128 v[108:111], v141 offset:1024
s_waitcnt lgkmcnt(5)
v_pk_add_f32 v[128:129], v[128:129], v[120:121]
v_pk_add_f32 v[130:131], v[130:131], v[122:123]
s_waitcnt lgkmcnt(4)
v_pk_add_f32 v[132:133], v[132:133], v[124:125]
v_pk_add_f32 v[134:135], v[134:135], v[126:127]
s_waitcnt lgkmcnt(3)
v_pk_add_f32 v[128:129], v[128:129], v[112:113]
v_pk_add_f32 v[130:131], v[130:131], v[114:115]
s_waitcnt lgkmcnt(2)
v_pk_add_f32 v[132:133], v[132:133], v[116:117]
v_pk_add_f32 v[134:135], v[134:135], v[118:119]
s_waitcnt lgkmcnt(1)
v_pk_add_f32 v[128:129], v[128:129], v[104:105]
v_pk_add_f32 v[130:131], v[130:131], v[106:107]
s_waitcnt lgkmcnt(0)
v_pk_add_f32 v[132:133], v[132:133], v[108:109]
v_pk_add_f32 v[134:135], v[134:135], v[110:111]
s_waitcnt vmcnt(1)
v_lshlrev_b32 v56, 16, v60
v_and_b32 v57, 0xffff0000, v60
v_lshlrev_b32 v58, 16, v61
v_and_b32 v59, 0xffff0000, v61
v_lshlrev_b32 v60, 16, v62
v_and_b32 v61, 0xffff0000, v62
v_lshlrev_b32 v62, 16, v63
v_and_b32 v63, 0xffff0000, v63
v_pk_add_f32 v[128:129], v[128:129], v[56:57]
v_pk_add_f32 v[130:131], v[130:131], v[58:59]
v_pk_add_f32 v[132:133], v[132:133], v[60:61]
v_pk_add_f32 v[134:135], v[134:135], v[62:63]
v_cvt_pk_bf16_f32 v136, v128, v129
v_cvt_pk_bf16_f32 v138, v132, v133
v_cvt_pk_bf16_f32 v137, v130, v131
v_cvt_pk_bf16_f32 v139, v134, v135
v_permlane32_swap_b32 v136, v138
s_nop 0
v_permlane32_swap_b32 v137, v139
buffer_store_dwordx4 v[136:139], v41, s[40:43], s44 offen
s_endpgm
L_spin0:
s_mov_b32 s15, s11
L_rep0:

s_add_u32 s15, s15, 64
s_bitcmp1_b32 s15, 9
s_cbranch_scc1 L_vec0
s_buffer_load_dwordx2 s[0:1], s[48:51], s15 offset:0
s_waitcnt lgkmcnt(0)
s_cmp_lg_u64 s[0:1], s[16:17]
s_cbranch_scc0 L_back0
s_branch L_rep0
L_spin1:
s_mov_b32 s15, s90
L_rep1:

s_add_u32 s15, s15, 64
s_bitcmp1_b32 s15, 9
s_cbranch_scc1 L_vec1
s_buffer_load_dwordx4 s[0:3], s[48:51], s15 offset:2048
s_waitcnt lgkmcnt(0)
s_xor_b64 s[0:1], s[0:1], s[16:17]
s_xor_b64 s[2:3], s[2:3], s[16:17]
s_or_b64 s[0:1], s[0:1], s[2:3]
s_cbranch_scc0 L_back1
s_branch L_rep1
L_spin2:
s_mov_b32 s15, s13
L_rep2:

s_add_u32 s15, s15, 64
s_bitcmp1_b32 s15, 9
s_cbranch_scc1 L_vec2
s_buffer_load_dwordx2 s[0:1], s[48:51], s15 offset:0
s_waitcnt lgkmcnt(0)
s_cmp_lg_u64 s[0:1], s[16:17]
s_cbranch_scc0 L_back2
s_branch L_rep2
L_spin3:
s_mov_b32 s15, s13
L_rep3:

s_add_u32 s15, s15, 64
s_bitcmp1_b32 s15, 9
s_cbranch_scc1 L_vec3
s_buffer_load_dwordx2 s[0:1], s[48:51], s15 offset:1024
s_waitcnt lgkmcnt(0)
s_cmp_lg_u64 s[0:1], s[16:17]
s_cbranch_scc0 L_back3
s_branch L_rep3
L_spin4:
s_mov_b32 s15, s13
L_rep4:

s_add_u32 s15, s15, 64
s_bitcmp1_b32 s15, 9
s_cbranch_scc1 L_vec4
s_buffer_load_dwordx2 s[0:1], s[48:51], s15 offset:2048
s_waitcnt lgkmcnt(0)
s_cmp_lg_u64 s[0:1], s[16:17]
s_cbranch_scc0 L_back4
s_branch L_rep4
L_spin5:
s_mov_b32 s15, s13
L_rep5:

s_add_u32 s15, s15, 64
s_bitcmp1_b32 s15, 9
s_cbranch_scc1 L_vec5
s_buffer_load_dwordx2 s[0:1], s[48:51], s15 offset:3072
s_waitcnt lgkmcnt(0)
s_cmp_lg_u64 s[0:1], s[16:17]
s_cbranch_scc0 L_back5
s_branch L_rep5
L_spin6:
s_mov_b32 s15, s21
L_rep6:

s_add_u32 s15, s15, 256
s_bitcmp1_b32 s15, 9
s_cbranch_scc1 L_vec6
s_buffer_load_dword s0, s[48:51], s15 offset:0
s_waitcnt lgkmcnt(0)
s_cmp_lg_u32 s0, s14
s_cbranch_scc0 L_back6
s_branch L_rep6
L_spin7:
s_mov_b32 s15, s21
L_rep7:

s_add_u32 s15, s15, 256
s_bitcmp1_b32 s15, 9
s_cbranch_scc1 L_vec7
s_buffer_load_dword s0, s[48:51], s15 offset:1024
s_waitcnt lgkmcnt(0)
s_cmp_lg_u32 s0, s14
s_cbranch_scc0 L_back7
s_branch L_rep7
L_hot:
L_spinr:
v_mov_b32 v26, 0
s_mov_b32 s0, 1
s_sub_u32 s62, s62, 1
s_cmp_lt_i32 s62, 0
s_cbranch_scc1 L_backr
buffer_load_dword v27, v26, s[44:47], s86 offen sc1
s_waitcnt vmcnt(0)
v_readfirstlane_b32 s0, v27
s_nop 1
s_cmp_eq_u32 s0, 0
s_cbranch_scc1 L_spinr
s_branch L_backr
L_vec0:
v_and_b32 v26, 7, v1
v_min_u32 v26, 6, v26
L_vecp0:
s_sub_u32 s63, s63, 1
s_cmp_lt_i32 s63, 0
s_cbranch_scc1 L_slow0
buffer_load_ubyte v27, v26, s[48:51], s11 offen sc1
s_waitcnt vmcnt(0)
v_cmp_ne_u32 vcc, v25, v27
s_cbranch_vccnz L_vecp0
s_branch L_back0
L_slow0:
s_mov_b32 s17, -1
s_mov_b32 s14, -1
s_mov_b32 s15, s55
s_lshl_b32 s15, s15, 2
v_mov_b32 v27, s15
s_waitcnt vmcnt(0)
s_mov_b64 exec, 1
buffer_store_dword v25, v27, s[48:51], s11 offen offset:512 sc1
s_mov_b64 exec, -1
L_slowp0:
s_sub_u32 s62, s62, 1
s_cmp_lt_i32 s62, 0
s_cbranch_scc1 L_back0
v_lshlrev_b32 v28, 2, v26
buffer_load_ubyte v27, v26, s[48:51], s11 offen sc1
buffer_load_dword v28, v28, s[48:51], s11 offen offset:512 sc1
s_waitcnt vmcnt(0)
v_cmp_ne_u32 vcc, v25, v27
v_cmp_eq_u32 s[66:67], 0, v28
s_nop 1
s_and_b64 vcc, vcc, s[66:67]
s_cbranch_scc1 L_slowp0
s_branch L_back0
L_vec1:
v_and_b32 v26, 7, v1
v_min_u32 v26, 6, v26
v_and_or_b32 v26, v1, 8, v26
L_vecp1:
s_sub_u32 s63, s63, 1
s_cmp_lt_i32 s63, 0
s_cbranch_scc1 L_slow1
buffer_load_ubyte v27, v26, s[48:51], s90 offen offset:2048 sc1
s_waitcnt vmcnt(0)
v_cmp_ne_u32 vcc, v25, v27
s_cbranch_vccnz L_vecp1
s_branch L_back1
L_slow1:
s_mov_b32 s17, -1
s_mov_b32 s14, -1
s_lshl3_add_u32 s15, s54, s55
s_lshl_b32 s15, s15, 2
v_mov_b32 v27, s15
s_waitcnt vmcnt(0)
s_mov_b64 exec, 1
buffer_store_dword v25, v27, s[48:51], s90 offen offset:2560 sc1
s_mov_b64 exec, -1
L_slowp1:
s_sub_u32 s62, s62, 1
s_cmp_lt_i32 s62, 0
s_cbranch_scc1 L_back1
v_lshlrev_b32 v28, 2, v26
buffer_load_ubyte v27, v26, s[48:51], s90 offen offset:2048 sc1
buffer_load_dword v28, v28, s[48:51], s90 offen offset:2560 sc1
s_waitcnt vmcnt(0)
v_cmp_ne_u32 vcc, v25, v27
v_cmp_eq_u32 s[66:67], 0, v28
s_nop 1
s_and_b64 vcc, vcc, s[66:67]
s_cbranch_scc1 L_slowp1
s_branch L_back1
L_vec2:
v_and_b32 v26, 7, v1
v_min_u32 v26, 6, v26
L_vecp2:
s_sub_u32 s63, s63, 1
s_cmp_lt_i32 s63, 0
s_cbranch_scc1 L_slow2
buffer_load_ubyte v27, v26, s[48:51], s13 offen sc1
s_waitcnt vmcnt(0)
v_cmp_ne_u32 vcc, v25, v27
s_cbranch_vccnz L_vecp2
s_branch L_back2
L_slow2:
s_mov_b32 s17, -1
s_mov_b32 s14, -1
s_mov_b32 s15, s55
s_lshl_b32 s15, s15, 2
v_mov_b32 v27, s15
s_waitcnt vmcnt(0)
s_mov_b64 exec, 1
buffer_store_dword v25, v27, s[48:51], s13 offen offset:512 sc1
s_mov_b64 exec, -1
L_slowp2:
s_sub_u32 s62, s62, 1
s_cmp_lt_i32 s62, 0
s_cbranch_scc1 L_back2
v_lshlrev_b32 v28, 2, v26
buffer_load_ubyte v27, v26, s[48:51], s13 offen sc1
buffer_load_dword v28, v28, s[48:51], s13 offen offset:512 sc1
s_waitcnt vmcnt(0)
v_cmp_ne_u32 vcc, v25, v27
v_cmp_eq_u32 s[66:67], 0, v28
s_nop 1
s_and_b64 vcc, vcc, s[66:67]
s_cbranch_scc1 L_slowp2
s_branch L_back2
L_vec3:
v_and_b32 v26, 7, v1
v_min_u32 v26, 6, v26
L_vecp3:
s_sub_u32 s63, s63, 1
s_cmp_lt_i32 s63, 0
s_cbranch_scc1 L_slow3
buffer_load_ubyte v27, v26, s[48:51], s13 offen offset:1024 sc1
s_waitcnt vmcnt(0)
v_cmp_ne_u32 vcc, v25, v27
s_cbranch_vccnz L_vecp3
s_branch L_back3
L_slow3:
s_mov_b32 s17, -1
s_mov_b32 s14, -1
s_mov_b32 s15, s55
s_lshl_b32 s15, s15, 2
v_mov_b32 v27, s15
s_waitcnt vmcnt(0)
s_mov_b64 exec, 1
buffer_store_dword v25, v27, s[48:51], s13 offen offset:1536 sc1
s_mov_b64 exec, -1
L_slowp3:
s_sub_u32 s62, s62, 1
s_cmp_lt_i32 s62, 0
s_cbranch_scc1 L_back3
v_lshlrev_b32 v28, 2, v26
buffer_load_ubyte v27, v26, s[48:51], s13 offen offset:1024 sc1
buffer_load_dword v28, v28, s[48:51], s13 offen offset:1536 sc1
s_waitcnt vmcnt(0)
v_cmp_ne_u32 vcc, v25, v27
v_cmp_eq_u32 s[66:67], 0, v28
s_nop 1
s_and_b64 vcc, vcc, s[66:67]
s_cbranch_scc1 L_slowp3
s_branch L_back3
L_vec4:
v_and_b32 v26, 7, v1
v_min_u32 v26, 6, v26
L_vecp4:
s_sub_u32 s63, s63, 1
s_cmp_lt_i32 s63, 0
s_cbranch_scc1 L_slow4
buffer_load_ubyte v27, v26, s[48:51], s13 offen offset:2048 sc1
s_waitcnt vmcnt(0)
v_cmp_ne_u32 vcc, v25, v27
s_cbranch_vccnz L_vecp4
s_branch L_back4
L_slow4:
s_mov_b32 s17, -1
s_mov_b32 s14, -1
s_mov_b32 s15, s55
s_lshl_b32 s15, s15, 2
v_mov_b32 v27, s15
s_waitcnt vmcnt(0)
s_mov_b64 exec, 1
buffer_store_dword v25, v27, s[48:51], s13 offen offset:2560 sc1
s_mov_b64 exec, -1
L_slowp4:
s_sub_u32 s62, s62, 1
s_cmp_lt_i32 s62, 0
s_cbranch_scc1 L_back4
v_lshlrev_b32 v28, 2, v26
buffer_load_ubyte v27, v26, s[48:51], s13 offen offset:2048 sc1
buffer_load_dword v28, v28, s[48:51], s13 offen offset:2560 sc1
s_waitcnt vmcnt(0)
v_cmp_ne_u32 vcc, v25, v27
v_cmp_eq_u32 s[66:67], 0, v28
s_nop 1
s_and_b64 vcc, vcc, s[66:67]
s_cbranch_scc1 L_slowp4
s_branch L_back4
L_vec5:
v_and_b32 v26, 7, v1
v_min_u32 v26, 6, v26
L_vecp5:
s_sub_u32 s63, s63, 1
s_cmp_lt_i32 s63, 0
s_cbranch_scc1 L_slow5
buffer_load_ubyte v27, v26, s[48:51], s13 offen offset:3072 sc1
s_waitcnt vmcnt(0)
v_cmp_ne_u32 vcc, v25, v27
s_cbranch_vccnz L_vecp5
s_branch L_back5
L_slow5:
s_mov_b32 s17, -1
s_mov_b32 s14, -1
s_mov_b32 s15, s55
s_lshl_b32 s15, s15, 2
v_mov_b32 v27, s15
s_waitcnt vmcnt(0)
s_mov_b64 exec, 1
buffer_store_dword v25, v27, s[48:51], s13 offen offset:3584 sc1
s_mov_b64 exec, -1
L_slowp5:
s_sub_u32 s62, s62, 1
s_cmp_lt_i32 s62, 0
s_cbranch_scc1 L_back5
v_lshlrev_b32 v28, 2, v26
buffer_load_ubyte v27, v26, s[48:51], s13 offen offset:3072 sc1
buffer_load_dword v28, v28, s[48:51], s13 offen offset:3584 sc1
s_waitcnt vmcnt(0)
v_cmp_ne_u32 vcc, v25, v27
v_cmp_eq_u32 s[66:67], 0, v28
s_nop 1
s_and_b64 vcc, vcc, s[66:67]
s_cbranch_scc1 L_slowp5
s_branch L_back5
L_vec6:
v_and_b32 v26, 7, v1
v_min_u32 v26, 0, v26
L_vecp6:
s_sub_u32 s63, s63, 1
s_cmp_lt_i32 s63, 0
s_cbranch_scc1 L_slow6
buffer_load_ubyte v27, v26, s[48:51], s21 offen sc1
s_waitcnt vmcnt(0)
v_cmp_ne_u32 vcc, v25, v27
s_cbranch_vccnz L_vecp6
s_branch L_back6
L_slow6:
s_mov_b32 s17, -1
s_mov_b32 s14, -1
s_mov_b32 s15, 0
s_lshl_b32 s15, s15, 2
v_mov_b32 v27, s15
s_waitcnt vmcnt(0)
s_mov_b64 exec, 1
buffer_store_dword v25, v27, s[48:51], s22 offen offset:512 sc1
s_mov_b64 exec, -1
L_slowp6:
s_sub_u32 s62, s62, 1
s_cmp_lt_i32 s62, 0
s_cbranch_scc1 L_back6
v_lshlrev_b32 v28, 2, v26
buffer_load_ubyte v27, v26, s[48:51], s21 offen sc1
buffer_load_dword v28, v28, s[48:51], s21 offen offset:512 sc1
s_waitcnt vmcnt(0)
v_cmp_ne_u32 vcc, v25, v27
v_cmp_eq_u32 s[66:67], 0, v28
s_nop 1
s_and_b64 vcc, vcc, s[66:67]
s_cbranch_scc1 L_slowp6
s_branch L_back6
L_vec7:
v_and_b32 v26, 7, v1
v_min_u32 v26, 0, v26
L_vecp7:
s_sub_u32 s63, s63, 1
s_cmp_lt_i32 s63, 0
s_cbranch_scc1 L_slow7
buffer_load_ubyte v27, v26, s[48:51], s21 offen offset:1024 sc1
s_waitcnt vmcnt(0)
v_cmp_ne_u32 vcc, v25, v27
s_cbranch_vccnz L_vecp7
s_branch L_back7
L_slow7:
s_mov_b32 s17, -1
s_mov_b32 s14, -1
s_mov_b32 s15, 0
s_lshl_b32 s15, s15, 2
v_mov_b32 v27, s15
s_waitcnt vmcnt(0)
s_mov_b64 exec, 1
buffer_store_dword v25, v27, s[48:51], s22 offen offset:1536 sc1
s_mov_b64 exec, -1
L_slowp7:
s_sub_u32 s62, s62, 1
s_cmp_lt_i32 s62, 0
s_cbranch_scc1 L_back7
v_lshlrev_b32 v28, 2, v26
buffer_load_ubyte v27, v26, s[48:51], s21 offen offset:1024 sc1
buffer_load_dword v28, v28, s[48:51], s21 offen offset:1536 sc1
s_waitcnt vmcnt(0)
v_cmp_ne_u32 vcc, v25, v27
v_cmp_eq_u32 s[66:67], 0, v28
s_nop 1
s_and_b64 vcc, vcc, s[66:67]
s_cbranch_scc1 L_slowp7
s_branch L_back7
.p2align 12
s_endpgm
s_endpgm
s_endpgm
s_endpgm
s_endpgm
s_endpgm
s_endpgm
s_endpgm
s_endpgm
L_helper:
v_lshlrev_b32 v1, 7, v0
s_mov_b32 s50, 33554432
s_mov_b32 s51, 0x20000
s_mov_b32 s46, 256
s_mov_b32 s47, 0x20000
s_mov_b32 s30, 401408
s_mov_b32 s31, 0x20000
s_mov_b32 s34, 1605632
s_mov_b32 s35, 0x20000
s_mov_b32 s38, 1605632
s_mov_b32 s39, 0x20000
v_mov_b32 v4, 0
v_mov_b32 v5, 0
v_mov_b32 v6, 0
v_mov_b32 v7, 0
v_readfirstlane_b32 s65, v0
s_lshl_b32 s58, s56, 30
v_lshl_add_u32 v10, v0, 4, s58
s_mul_i32 s57, s53, 2097152
s_lshl_b32 s55, s53, 4
v_cmp_eq_u32 vcc, 0, v0
v_mov_b32 v8, 1073741824
v_mov_b32 v9, 1
v_cndmask_b32 v8, v8, v4, vcc
s_waitcnt lgkmcnt(0)
s_mov_b64 s[48:49], s[18:19]
s_mov_b64 s[44:45], s[16:17]
s_mov_b64 s[28:29], s[8:9]
s_mov_b64 s[32:33], s[10:11]
s_mov_b64 s[36:37], s[12:13]
buffer_store_dwordx4 v[4:7], v10, s[48:51], s57 offen sc1
v_add_u32 v10, 4096, v10
buffer_store_dwordx4 v[4:7], v10, s[48:51], s57 offen sc1
v_add_u32 v10, 4096, v10
buffer_store_dwordx4 v[4:7], v10, s[48:51], s57 offen sc1
v_add_u32 v10, 4096, v10
buffer_store_dwordx4 v[4:7], v10, s[48:51], s57 offen sc1
v_lshlrev_b32 v10, 6, v0
v_min_u32 v10, 13248, v10
L_htouch:
s_lshl1_add_u32 s54, s53, s56
s_waitcnt vmcnt(4)
s_mul_i32 s58, s54, 12544
v_min_u32 v2, 12416, v1
buffer_load_dword v20, v2, s[28:31], s58 offen
s_mul_i32 s58, s54, 19712
v_min_u32 v2, 19584, v1
buffer_load_dword v21, v2, s[32:35], s58 offen
s_mul_i32 s58, s54, 30464
s_add_u32 s58, s58, 630784
v_min_u32 v2, 30336, v1
buffer_load_dword v22, v2, s[32:35], s58 offen
s_cmp_lg_u32 s56, 0
s_cbranch_scc1 L_hnoflag
s_waitcnt vmcnt(3) lgkmcnt(0)
s_barrier
s_cmp_ge_u32 s65, 64
s_cbranch_scc1 L_hwait
L_hrace:
s_mov_b64 s[0:1], -1
s_buffer_load_dword s1, s[48:51], s57 offset:8832
s_buffer_load_dword s0, s[48:51], s57 offset:640
s_waitcnt lgkmcnt(1)
s_sub_u32 s52, s1, s0
s_waitcnt lgkmcnt(0)
s_mov_b64 s[0:1], -1
s_buffer_load_dword s0, s[48:51], s57 offset:768
s_buffer_load_dword s1, s[48:51], s57 offset:8960
s_waitcnt lgkmcnt(1)
s_sub_u32 s61, s1, s0
s_waitcnt lgkmcnt(0)
s_add_u32 s52, s52, s61
s_cmp_lg_u32 s52, 0
s_cbranch_scc1 L_hknown
s_mov_b64 s[0:1], -1
s_buffer_load_dword s1, s[48:51], s57 offset:9088
s_buffer_load_dword s0, s[48:51], s57 offset:896
s_waitcnt lgkmcnt(1)
s_sub_u32 s52, s1, s0
s_waitcnt lgkmcnt(0)
L_hknown:
s_cmp_gt_i32 s52, 0
s_cselect_b32 s52, 0x2001, 1
v_mov_b32 v9, s52
buffer_store_dword v9, v8, s[44:47], s55 offen sc1
L_hwait:
s_barrier
buffer_load_dword v16, v10, s[48:51], s57 offen sc1
L_hnoflag:
s_mul_i32 s58, s54, 50176
buffer_load_dword v23, v1, s[36:39], s58 offen
s_add_u32 s58, s58, 32768
v_min_u32 v2, 17280, v1
buffer_load_dword v24, v2, s[36:39], s58 offen
s_waitcnt vmcnt(0)
L_end:
s_endpgm
.section .rodata,"a"
.p2align 6
.amdhsa_kernel standalone__mixer_s_mlp__prompt_kernel
  .amdhsa_next_free_vgpr 512
  .amdhsa_next_free_sgpr 102
  .amdhsa_accum_offset 256
  .amdhsa_group_segment_fixed_size 0
  .amdhsa_kernarg_size 64
  .amdhsa_user_sgpr_count 2
  .amdhsa_user_sgpr_kernarg_segment_ptr 1
  .amdhsa_system_sgpr_workgroup_id_x 1
.end_amdhsa_kernel
```
